```python
import torch

def _softmax(x, axis=-1):
    return torch.softmax(x, dim=axis)
def _gelu(x):
    return torch.nn.functional.gelu(x, approximate="tanh")
def _silu(x):
    return torch.nn.functional.silu(x)
def _sigmoid(x):
    return torch.sigmoid(x)
def _layernorm(x, axis=-1, eps=1e-5):
    m = x.mean(dim=axis, keepdim=True)
    v = x.var(dim=axis, keepdim=True, unbiased=False)
    return (x - m) / torch.sqrt(v + eps)
def _scatter_add(tgt, idx, src, axis=0):
    return tgt.clone().index_add_(axis, idx, src)
def _segment_sum(src, seg, n):
    out = torch.zeros((n,) + src.shape[1:], dtype=src.dtype)
    return out.index_add_(0, seg, src)
def _pad(x, pw):
    flat = tuple(v for pair in reversed(pw) for v in pair)
    return torch.nn.functional.pad(x, flat)

kernel_name = 'concat_heads__gqa_block_cached__gqa_block_cached__near_ridge'

def setup_inputs():

    _w = (lambda a: (lambda t: t.to(torch.bfloat16) if t.is_floating_point() else t)(torch.as_tensor(a)))
    def _A_setup():
        B, Sq, D = 16, 32, 640
        Hq, Hkv, Sk, Dh = 32, 32, 32, 192
        assert Hq % Hkv == 0, (Hq, Hkv)
        return {
            "x": _w((lambda *s: torch.randn(*s, dtype=torch.bfloat16) * 0.8)(B, Sq, D)),
            "k_cache": _w((lambda *s: torch.randn(*s, dtype=torch.bfloat16) * 0.8)(B, Hkv, Sk, Dh)),
            "v_cache": _w((lambda *s: torch.randn(*s, dtype=torch.bfloat16) * 0.05)(B, Hkv, Sk, Dh)),
            "wq": _w((lambda *s: torch.randn(*s, dtype=torch.bfloat16) * 0.8)(D, Hq * Dh) * (D ** -0.5)),
            "wo": _w((lambda *s: torch.randn(*s, dtype=torch.bfloat16) * 0.05)(Hq * Dh, D) * ((Hq * Dh) ** -0.5)),
        }
    _A_in = _A_setup()

    def _B_setup():
        B, Sq, D = 16, 32, 640
        Hq, Hkv, Sk, Dh = 32, 32, 32, 192
        assert Hq % Hkv == 0, (Hq, Hkv)
        return {
            "x": _w((lambda *s: torch.randn(*s, dtype=torch.bfloat16) * 0.8)(B, Sq, D)),
            "k_cache": _w((lambda *s: torch.randn(*s, dtype=torch.bfloat16) * 0.8)(B, Hkv, Sk, Dh)),
            "v_cache": _w((lambda *s: torch.randn(*s, dtype=torch.bfloat16) * 0.05)(B, Hkv, Sk, Dh)),
            "wq": _w((lambda *s: torch.randn(*s, dtype=torch.bfloat16) * 0.8)(D, Hq * Dh) * (D ** -0.5)),
            "wo": _w((lambda *s: torch.randn(*s, dtype=torch.bfloat16) * 0.05)(Hq * Dh, D) * ((Hq * Dh) ** -0.5)),
        }
    _B_in = _B_setup()

    return {
        "A_x": _A_in["x"],
        "A_k_cache": _A_in["k_cache"],
        "A_v_cache": _A_in["v_cache"],
        "A_wq": _A_in["wq"],
        "A_wo": _A_in["wo"],
        "B_x": _B_in["x"],
        "B_k_cache": _B_in["k_cache"],
        "B_v_cache": _B_in["v_cache"],
        "B_wq": _B_in["wq"],
        "B_wo": _B_in["wo"],
    }

def reference(A_x, A_k_cache, A_v_cache, A_wq, A_wo, B_x, B_k_cache, B_v_cache, B_wq, B_wo):
    def _A_ref(x, k_cache, v_cache, wq, wo):
        B, Sq, D = x.shape
        Hq, Dh = 32, 192
        Hkv = k_cache.shape[1]
        rep = Hq // Hkv
        q = (lambda x, *d: x.permute(*d))((x @ wq).reshape(B, Sq, Hq, Dh), 0, 2, 1, 3)
        k = (lambda x, n, axis: torch.repeat_interleave(x, n, dim=axis))(k_cache, rep, axis=1)
        v = (lambda x, n, axis: torch.repeat_interleave(x, n, dim=axis))(v_cache, rep, axis=1)
        scores = torch.einsum("bhqd,bhkd->bhqk", q, k) * (Dh ** -0.5)
        p = _softmax(scores, axis=-1)
        o = torch.einsum("bhqk,bhkd->bhqd", p, v)
        return (lambda x, *d: x.permute(*d))(o, 0, 2, 1, 3).reshape(B, Sq, Hq * Dh) @ wo

    def _B_ref(x, k_cache, v_cache, wq, wo):
        B, Sq, D = x.shape
        Hq, Dh = 32, 192
        Hkv = k_cache.shape[1]
        rep = Hq // Hkv
        q = (lambda x, *d: x.permute(*d))((x @ wq).reshape(B, Sq, Hq, Dh), 0, 2, 1, 3)
        k = (lambda x, n, axis: torch.repeat_interleave(x, n, dim=axis))(k_cache, rep, axis=1)
        v = (lambda x, n, axis: torch.repeat_interleave(x, n, dim=axis))(v_cache, rep, axis=1)
        scores = torch.einsum("bhqd,bhkd->bhqk", q, k) * (Dh ** -0.5)
        p = _softmax(scores, axis=-1)
        o = torch.einsum("bhqk,bhkd->bhqd", p, v)
        return (lambda x, *d: x.permute(*d))(o, 0, 2, 1, 3).reshape(B, Sq, Hq * Dh) @ wo

    a = _A_ref(A_x, A_k_cache, A_v_cache, A_wq, A_wo)
    b = _B_ref(B_x, B_k_cache, B_v_cache, B_wq, B_wo)
    return torch.concatenate([a, b], axis=-1)
```

```asm
; @launch grid=(256,1,1) block=(512,1,1) lds=163840
.amdgcn_target "amdgcn-amd-amdhsa--gfx950"
.text
.globl concat_heads__gqa_block_cached__gqa_block_cached__near_ridge_kernel
.p2align 8
.type concat_heads__gqa_block_cached__gqa_block_cached__near_ridge_kernel,@function
concat_heads__gqa_block_cached__gqa_block_cached__near_ridge_kernel:
    s_cmp_ge_u32 s2, 256
    s_cbranch_scc1 L_end
    s_bfe_u32 s36, s2, 0x10002
    s_mul_i32 s6, s36, 40
    s_load_dwordx2 s[8:9], s[0:1], s6
    s_load_dwordx2 s[20:21], s[0:1], s6 offset:24
    v_lshrrev_b32 v1, 6, v0
    s_and_b32 s4, s2, 3
    v_readfirstlane_b32 s3, v1
    s_lshr_b32 s7, s2, 5
    s_bfe_u32 s37, s2, 0x20003
    s_lshl3_add_u32 s38, s4, s7
    v_and_b32 v0, 63, v0
    s_and_b32 s41, s3, 3
    s_lshl2_add_u32 s43, s37, s41
    s_cmp_lt_u32 s3, 4
    s_cbranch_scc1 L_consumer
    s_setprio 3
    v_lshrrev_b32 v1, 3, v0
    v_lshrrev_b32 v2, 4, v0
    v_and_b32 v3, 7, v0
    v_and_b32 v24, 2, v1
    v_xor_b32 v24, v24, v3
    v_xor_b32 v3, v3, v2
    v_lshlrev_b32 v3, 4, v3
    v_xor_b32 v2, 64, v3
    v_mul_u32_u24 v4, 1280, v1
    v_add_u32 v5, v4, v2
    v_add_u32 v4, v4, v3
    v_add_u32 v6, 18432, v4
    v_add_u32 v7, 27648, v5
    v_add_u32 v5, 9216, v5
    s_mul_i32 s44, s43, 40960
    s_lshl_b32 s71, s41, 12
    s_lshl_b32 s4, s7, 2
    s_lshr_b32 s75, 0x11230203, s4
    s_and_b32 s75, s75, 15
    s_mov_b32 s10, 655360
    s_mov_b32 s11, 0x00020000
    s_add_u32 s68, s37, s75
    s_cmp_ge_u32 s68, 10
    s_cselect_b32 s4, 10, 0
    s_sub_u32 s68, s68, s4
    s_lshl_b32 s69, s68, 7
    s_add_u32 s69, s69, s44
    s_waitcnt lgkmcnt(0)
    s_add_u32 m0, s71, 0
    s_nop 0
    buffer_load_dwordx4 v4, s[8:11], s69 offen offset:0  lds
    buffer_load_dwordx4 v5, s[8:11], s69 offen offset:1024  lds
    buffer_load_dwordx4 v6, s[8:11], s69 offen offset:2048  lds
    buffer_load_dwordx4 v7, s[8:11], s69 offen offset:3072  lds
    v_mul_u32_u24 v25, 12288, v1
    v_lshl_add_u32 v24, v24, 4, v25
    s_lshl_b32 s4, s41, 6
    s_and_b32 s4, s4, 64
    v_xor_b32 v24, s4, v24
    v_add_u32 v12, 4096, v24
    v_add_u32 v13, 3200, v24
    v_add_u32 v14, 2304, v24
    v_add_u32 v15, 397312, v24
    v_add_u32 v16, 396416, v24
    v_add_u32 v17, 395520, v24
    s_mul_i32 s45, s38, 384
    s_mul_i32 s4, s41, 98304
    s_add_u32 s45, s45, s4
    s_mul_i32 s74, s41, 3072
    s_add_u32 s74, s74, 16384
    s_mov_b32 s22, 7868416
    s_mov_b32 s23, 0x00020000
    s_mul_i32 s70, s68, 786432
    s_add_u32 s70, s70, s45
    s_sub_u32 s20, s20, 4096
    s_subb_u32 s21, s21, 0
    s_add_u32 m0, s74, 0
    s_nop 0
    buffer_load_dwordx4 v12, s[20:23], s70 offen offset:0  lds
    buffer_load_dwordx4 v13, s[20:23], s70 offen offset:1024  lds
    buffer_load_dwordx4 v14, s[20:23], s70 offen offset:2048  lds
    s_add_u32 m0, m0, 12288
    s_nop 0
    buffer_load_dwordx4 v15, s[20:23], s70 offen offset:0  lds
    buffer_load_dwordx4 v16, s[20:23], s70 offen offset:1024  lds
    buffer_load_dwordx4 v17, s[20:23], s70 offen offset:2048  lds
    s_setprio 0
    s_load_dwordx2 s[12:13], s[0:1], s6 offset:8
    s_load_dwordx2 s[16:17], s[0:1], s6 offset:16
    s_load_dwordx2 s[24:25], s[0:1], s6 offset:32
    s_load_dwordx2 s[28:29], s[0:1], 96
    s_load_dwordx2 s[32:33], s[0:1], 88
    s_load_dwordx2 s[48:49], s[0:1], 80
    s_mov_b32 s72, 0x76583214
    s_mov_b32 s73, 0x9
    s_cmp_eq_u32 s37, 1
    s_cselect_b32 s72, 0x76943250, s72
    s_cselect_b32 s73, 0x8, s73
    s_cmp_eq_u32 s37, 2
    s_cselect_b32 s72, 0x87543610, s72
    s_cselect_b32 s73, 0x9, s73
    s_cmp_eq_u32 s37, 3
    s_cselect_b32 s72, 0x86547210, s72
    s_cselect_b32 s73, 0x9, s73
    s_and_b32 s68, s72, 15
    s_add_u32 s68, s68, s75
    s_cmp_ge_u32 s68, 10
    s_cselect_b32 s4, 10, 0
    s_sub_u32 s68, s68, s4
    s_lshl_b32 s69, s68, 7
    s_add_u32 s69, s69, s44
    s_mul_i32 s70, s68, 786432
    s_lshr_b64 s[72:73], s[72:73], 4
    s_add_u32 s70, s70, s45
    s_add_u32 m0, s74, 40960
    s_nop 0
    buffer_load_dwordx4 v12, s[20:23], s70 offen offset:0  lds
    buffer_load_dwordx4 v13, s[20:23], s70 offen offset:1024  lds
    buffer_load_dwordx4 v14, s[20:23], s70 offen offset:2048  lds
    s_add_u32 m0, m0, 12288
    s_nop 0
    buffer_load_dwordx4 v15, s[20:23], s70 offen offset:0  lds
    s_lshr_b32 s39, s38, 2
    s_and_b32 s40, s38, 3
    s_lshl2_add_u32 s42, s36, s37
    v_mul_u32_u24 v25, 384, v1
    v_add_u32 v8, v25, v3
    v_add_u32 v9, v25, v2
    v_add_u32 v9, 2048, v9
    v_add_u32 v10, v25, v3
    v_add_u32 v10, 4096, v10
    v_add_u32 v11, v25, v2
    v_add_u32 v11, 6144, v11
    s_waitcnt lgkmcnt(0)
    s_mul_i32 s6, s43, 393216
    s_mul_i32 s5, s38, 12288
    s_add_u32 s6, s6, s5
    s_mov_b32 s14, 6291456
    s_mov_b32 s15, 0x00020000
    s_mov_b32 s34, 256
    s_mov_b32 s35, 0x00020000
    s_lshl_b32 s4, s37, 3
    s_lshr_b32 s7, 0x62847373, s4
    s_mov_b32 s47, 2
    s_mov_b32 s46, 81920
    s_mov_b32 s18, 6291456
    s_mov_b32 s19, 0x00020000
    s_mul_i32 s63, s43, 393216
    s_lshl_b32 s4, s37, 2
    s_lshr_b32 s62, 0x2110, s4
    s_and_b32 s62, s62, 15
    s_lshl_b32 s4, s37, 3
    s_lshr_b32 s55, 0xb4e4b4e4, s4
    v_add_u32 v24, 0, v0
    v_mul_u32_u24 v25, 3277, v24
    v_lshrrev_b32 v25, 16, v25
    v_mul_u32_u24 v26, 20, v25
    v_sub_u32 v26, v24, v26
    v_lshrrev_b32 v27, 2, v25
    v_and_b32 v27, 2, v27
    v_xor_b32 v26, v26, v27
    v_lshlrev_b32 v26, 4, v26
    v_mul_u32_u24 v25, 1280, v25
    v_add_u32 v25, v25, v26
    v_subrev_u32 v18, 0, v25
    v_add_u32 v24, 64, v0
    v_mul_u32_u24 v25, 3277, v24
    v_lshrrev_b32 v25, 16, v25
    v_mul_u32_u24 v26, 20, v25
    v_sub_u32 v26, v24, v26
    v_lshrrev_b32 v27, 2, v25
    v_and_b32 v27, 2, v27
    v_xor_b32 v26, v26, v27
    v_lshlrev_b32 v26, 4, v26
    v_mul_u32_u24 v25, 1280, v25
    v_add_u32 v25, v25, v26
    v_subrev_u32 v19, 1024, v25
    v_add_u32 v24, 128, v0
    v_mul_u32_u24 v25, 3277, v24
    v_lshrrev_b32 v25, 16, v25
    v_mul_u32_u24 v26, 20, v25
    v_sub_u32 v26, v24, v26
    v_lshrrev_b32 v27, 2, v25
    v_and_b32 v27, 2, v27
    v_xor_b32 v26, v26, v27
    v_lshlrev_b32 v26, 4, v26
    v_mul_u32_u24 v25, 1280, v25
    v_add_u32 v25, v25, v26
    v_subrev_u32 v20, 2048, v25
    v_add_u32 v24, 192, v0
    v_mul_u32_u24 v25, 3277, v24
    v_lshrrev_b32 v25, 16, v25
    v_mul_u32_u24 v26, 20, v25
    v_sub_u32 v26, v24, v26
    v_lshrrev_b32 v27, 2, v25
    v_and_b32 v27, 2, v27
    v_xor_b32 v26, v26, v27
    v_lshlrev_b32 v26, 4, v26
    v_mul_u32_u24 v25, 1280, v25
    v_add_u32 v25, v25, v26
    v_subrev_u32 v21, 3072, v25
    v_add_u32 v24, 256, v0
    v_mul_u32_u24 v25, 3277, v24
    v_lshrrev_b32 v25, 16, v25
    v_mul_u32_u24 v26, 20, v25
    v_sub_u32 v26, v24, v26
    v_lshrrev_b32 v27, 2, v25
    v_and_b32 v27, 2, v27
    v_xor_b32 v26, v26, v27
    v_lshlrev_b32 v26, 4, v26
    v_mul_u32_u24 v25, 1280, v25
    v_add_u32 v25, v25, v26
    v_subrev_u32 v22, 0, v25
    v_lshlrev_b32 v23, 4, v0
    s_mov_b32 s26, 7864320
    s_mov_b32 s27, 0x00020000
    s_mov_b32 s30, 268435456
    s_mov_b32 s31, 0x00020000
    s_mul_i32 s58, s41, 20480
    s_mul_i32 s4, s40, 320
    s_add_u32 s58, s58, s4
    s_mul_i32 s59, s41, 5120
    s_add_u32 s59, s59, 16384
    s_lshl_b32 s4, s42, 7
    s_add_u32 s4, s4, s41
    s_lshl_b32 s60, s4, 11
    s_bfe_u32 s4, s38, 0x10003
    s_xor_b32 s4, s4, 1
    s_xor_b32 s4, s4, s41
    s_lshl_b32 s61, s4, 11
    v_lshlrev_b32 v31, 12, v0
    v_cmp_gt_u32 vcc, 4, v0
    v_bfrev_b32 v24, 1
    s_nop 0
    v_cndmask_b32 v31, v24, v31, vcc
    v_cmp_ne_u32 vcc, s40, v0
    s_nop 1
    v_cndmask_b32 v31, v24, v31, vcc
    s_lshl_b32 s4, s42, 5
    s_add_u32 s4, s4, s39
    s_lshl_b32 s4, s4, 2
    s_add_u32 s4, s4, s41
    s_lshl_b32 s51, s4, 7
    s_add_u32 s51, s51, 3145728
    s_lshl_b32 s4, s62, 7
    s_add_u32 s4, s4, s6
    s_add_u32 s64, s16, s4
    s_addc_u32 s65, s17, 0
    s_mov_b32 s67, 64
    s_waitcnt vmcnt(7)
    s_barrier
    buffer_load_dwordx4 v16, s[20:23], s70 offen offset:1024  lds
    buffer_load_dwordx4 v17, s[20:23], s70 offen offset:2048  lds
    s_add_u32 m0, s71, 40960
    s_nop 0
    buffer_load_dwordx4 v4, s[8:11], s69 offen offset:0  lds
    s_waitcnt vmcnt(7)
    s_barrier
    buffer_load_dwordx4 v5, s[8:11], s69 offen offset:1024  lds
    buffer_load_dwordx4 v6, s[8:11], s69 offen offset:2048  lds
    buffer_load_dwordx4 v7, s[8:11], s69 offen offset:3072  lds
    s_and_b32 s68, s72, 15
    s_add_u32 s68, s68, s75
    s_cmp_ge_u32 s68, 10
    s_cselect_b32 s4, 10, 0
    s_sub_u32 s68, s68, s4
    s_lshl_b32 s69, s68, 7
    s_add_u32 s69, s69, s44
    s_mul_i32 s70, s68, 786432
    s_lshr_b64 s[72:73], s[72:73], 4
    s_add_u32 s70, s70, s45
L_ld1:
    s_and_b32 s4, s7, 15
    s_cmp_eq_u32 s4, s47
    s_cbranch_scc1 L_ld1_k
    s_add_u32 m0, s74, s46
    s_nop 0
    buffer_load_dwordx4 v12, s[20:23], s70 offen offset:0  lds
    buffer_load_dwordx4 v13, s[20:23], s70 offen offset:1024  lds
    buffer_load_dwordx4 v14, s[20:23], s70 offen offset:2048  lds
    s_add_u32 m0, m0, 12288
    s_nop 0
    buffer_load_dwordx4 v15, s[20:23], s70 offen offset:0  lds
    buffer_load_dwordx4 v16, s[20:23], s70 offen offset:1024  lds
    buffer_load_dwordx4 v17, s[20:23], s70 offen offset:2048  lds
    s_cmp_lt_u32 s47, 4
    s_cbranch_scc1 L_nosb1
    s_cmp_eq_u32 s67, 0
    s_cbranch_scc1 L_nosb1
    s_load_dword s66, s[64:65], 0
    s_load_dword s66, s[64:65], 64
    s_load_dword s66, s[64:65], 384
    s_load_dword s66, s[64:65], 448
    s_cmp_eq_u32 s67, 4
    s_cselect_b32 s67, 0, s67
    s_cbranch_scc1 L_nosb1
    s_load_dword s66, s[64:65], 768
    s_load_dword s66, s[64:65], 832
    s_load_dword s66, s[64:65], 1152
    s_load_dword s66, s[64:65], 1216
    s_load_dword s66, s[64:65], 1536
    s_load_dword s66, s[64:65], 1600
    s_load_dword s66, s[64:65], 1920
    s_load_dword s66, s[64:65], 1984
    s_add_u32 s64, s64, 2304
    s_addc_u32 s65, s65, 0
    s_sub_u32 s67, s67, 12
L_nosb1:
    s_add_u32 m0, s71, s46
    s_nop 0
    buffer_load_dwordx4 v4, s[8:11], s69 offen offset:0  lds
    buffer_load_dwordx4 v5, s[8:11], s69 offen offset:1024  lds
    s_waitcnt vmcnt(8)
    s_barrier
    buffer_load_dwordx4 v6, s[8:11], s69 offen offset:2048  lds
    buffer_load_dwordx4 v7, s[8:11], s69 offen offset:3072  lds
L_ld1_end:
    s_add_u32 s47, s47, 1
    s_add_u32 s46, s46, 40960
    s_cmp_ge_u32 s46, 122880
    s_cselect_b32 s46, 0, s46
    s_and_b32 s68, s72, 15
    s_add_u32 s68, s68, s75
    s_cmp_ge_u32 s68, 10
    s_cselect_b32 s4, 10, 0
    s_sub_u32 s68, s68, s4
    s_lshl_b32 s69, s68, 7
    s_add_u32 s69, s69, s44
    s_mul_i32 s70, s68, 786432
    s_lshr_b64 s[72:73], s[72:73], 4
    s_add_u32 s70, s70, s45
    s_cmp_lt_u32 s47, 10
    s_cbranch_scc1 L_ld1
    s_mov_b32 s54, s62
    s_lshl_b32 s71, s61, 1
    s_add_u32 s4, s40, 0
    s_and_b32 s4, s4, 3
    s_lshl2_add_u32 s52, s39, s4
    s_mul_i32 s52, s52, 12288
    s_add_u32 s52, s52, s63
    s_lshl_b32 s4, s62, 7
    s_add_u32 s69, s52, s4
    s_add_u32 s4, s40, 0
    s_and_b32 s4, s4, 3
    s_lshl2_add_u32 s53, s39, s4
    s_mul_i32 s53, s53, 245760
    s_add_u32 s53, s53, s58
    s_mul_i32 s4, s54, 81920
    s_add_u32 s70, s53, s4
    s_add_u32 m0, s59, 40960
    s_nop 0
    buffer_load_dwordx4 v18, s[24:27], s70 offen offset:0  lds
    buffer_load_dwordx4 v19, s[24:27], s70 offen offset:1024  lds
    buffer_load_dwordx4 v20, s[24:27], s70 offen offset:2048  lds
    buffer_load_dwordx4 v21, s[24:27], s70 offen offset:3072  lds
    s_add_u32 m0, m0, 4096
    s_nop 0
    buffer_load_dwordx4 v22, s[24:27], s70 offen offset:0  lds
    s_add_u32 s54, s54, 1
    s_cmp_eq_u32 s54, 3
    s_cselect_b32 s54, 0, s54
    s_mul_i32 s4, s54, 81920
    s_add_u32 s70, s53, s4
    s_add_u32 m0, s71, 40960
    s_nop 0
    buffer_load_dwordx4 v8, s[16:19], s69 offen offset:0  lds
    buffer_load_dwordx4 v9, s[16:19], s69 offen offset:1024  lds
    s_waitcnt vmcnt(7)
    s_barrier
    buffer_load_dwordx4 v10, s[16:19], s69 offen offset:2048  lds
    buffer_load_dwordx4 v11, s[16:19], s69 offen offset:3072  lds
    s_add_u32 s62, s62, 1
    s_cmp_eq_u32 s62, 3
    s_cselect_b32 s62, 0, s62
    s_lshl_b32 s4, s62, 7
    s_add_u32 s69, s52, s4
    s_lshl_b32 s7, s42, 5
    buffer_load_dword v28, off, s[32:35], s7 sc1
    s_add_u32 m0, s71, 81920
    s_nop 0
    buffer_load_dwordx4 v8, s[16:19], s69 offen offset:0  lds
    buffer_load_dwordx4 v9, s[16:19], s69 offen offset:1024  lds
    buffer_load_dwordx4 v10, s[16:19], s69 offen offset:2048  lds
    buffer_load_dwordx4 v11, s[16:19], s69 offen offset:3072  lds
    s_add_u32 s62, s62, 1
    s_cmp_eq_u32 s62, 3
    s_cselect_b32 s62, 0, s62
    s_lshl_b32 s4, s62, 7
    s_add_u32 s69, s52, s4
    s_add_u32 m0, s59, 81920
    s_nop 0
    buffer_load_dwordx4 v18, s[24:27], s70 offen offset:0  lds
    buffer_load_dwordx4 v19, s[24:27], s70 offen offset:1024  lds
    buffer_load_dwordx4 v20, s[24:27], s70 offen offset:2048  lds
    s_waitcnt vmcnt(8)
    s_barrier
    buffer_load_dwordx4 v21, s[24:27], s70 offen offset:3072  lds
    s_add_u32 m0, m0, 4096
    s_nop 0
    buffer_load_dwordx4 v22, s[24:27], s70 offen offset:0  lds
    s_add_u32 s54, s54, 1
    s_cmp_eq_u32 s54, 3
    s_cselect_b32 s54, 0, s54
    s_mul_i32 s4, s54, 81920
    s_add_u32 s70, s53, s4
    s_waitcnt vmcnt(9)
L_mark_chk:
    v_readfirstlane_b32 s5, v28
    s_nop 3
    s_cmp_eq_u32 s5, 32
    s_cbranch_scc0 L_mark_spin
    s_add_u32 m0, s71, 0
    s_nop 0
    buffer_load_dwordx4 v8, s[16:19], s69 offen offset:0  lds
    buffer_load_dwordx4 v9, s[16:19], s69 offen offset:1024  lds
    buffer_load_dwordx4 v10, s[16:19], s69 offen offset:2048  lds
    buffer_load_dwordx4 v11, s[16:19], s69 offen offset:3072  lds
    s_add_u32 s62, s62, 1
    s_cmp_eq_u32 s62, 3
    s_cselect_b32 s62, 0, s62
    s_add_u32 s4, s40, 1
    s_and_b32 s4, s4, 3
    s_lshl2_add_u32 s52, s39, s4
    s_mul_i32 s52, s52, 12288
    s_add_u32 s52, s52, s63
    s_lshl_b32 s4, s62, 7
    s_add_u32 s69, s52, s4
    s_add_u32 m0, s59, 0
    s_nop 0
    buffer_load_dwordx4 v18, s[24:27], s70 offen offset:0  lds
    buffer_load_dwordx4 v19, s[24:27], s70 offen offset:1024  lds
    buffer_load_dwordx4 v20, s[24:27], s70 offen offset:2048  lds
    s_waitcnt vmcnt(7)
    s_barrier
    buffer_load_dwordx4 v21, s[24:27], s70 offen offset:3072  lds
    s_add_u32 m0, m0, 4096
    s_nop 0
    buffer_load_dwordx4 v22, s[24:27], s70 offen offset:0  lds
    s_add_u32 s54, s54, 1
    s_cmp_eq_u32 s54, 3
    s_cselect_b32 s54, 0, s54
    s_add_u32 s4, s40, 1
    s_and_b32 s4, s4, 3
    s_lshl2_add_u32 s53, s39, s4
    s_mul_i32 s53, s53, 245760
    s_add_u32 s53, s53, s58
    s_mul_i32 s4, s54, 81920
    s_add_u32 s70, s53, s4
    s_add_u32 m0, s59, 40960
    s_nop 0
    buffer_load_dwordx4 v18, s[24:27], s70 offen offset:0  lds
    buffer_load_dwordx4 v19, s[24:27], s70 offen offset:1024  lds
    buffer_load_dwordx4 v20, s[24:27], s70 offen offset:2048  lds
    buffer_load_dwordx4 v21, s[24:27], s70 offen offset:3072  lds
    s_add_u32 m0, m0, 4096
    s_nop 0
    buffer_load_dwordx4 v22, s[24:27], s70 offen offset:0  lds
    s_add_u32 s54, s54, 1
    s_cmp_eq_u32 s54, 3
    s_cselect_b32 s54, 0, s54
    s_mul_i32 s4, s54, 81920
    s_add_u32 s70, s53, s4
    s_add_u32 m0, s71, 40960
    s_nop 0
    buffer_load_dwordx4 v8, s[16:19], s69 offen offset:0  lds
    buffer_load_dwordx4 v9, s[16:19], s69 offen offset:1024  lds
    s_waitcnt vmcnt(7)
    s_barrier
    buffer_load_dwordx4 v10, s[16:19], s69 offen offset:2048  lds
    buffer_load_dwordx4 v11, s[16:19], s69 offen offset:3072  lds
    s_add_u32 s62, s62, 1
    s_cmp_eq_u32 s62, 3
    s_cselect_b32 s62, 0, s62
    s_lshl_b32 s4, s62, 7
    s_add_u32 s69, s52, s4
    s_add_u32 m0, s59, 81920
    s_nop 0
    buffer_load_dwordx4 v18, s[24:27], s70 offen offset:0  lds
    buffer_load_dwordx4 v19, s[24:27], s70 offen offset:1024  lds
    buffer_load_dwordx4 v20, s[24:27], s70 offen offset:2048  lds
    buffer_load_dwordx4 v21, s[24:27], s70 offen offset:3072  lds
    s_add_u32 m0, m0, 4096
    s_nop 0
    buffer_load_dwordx4 v22, s[24:27], s70 offen offset:0  lds
    s_add_u32 s54, s54, 1
    s_cmp_eq_u32 s54, 3
    s_cselect_b32 s54, 0, s54
    s_mul_i32 s4, s54, 81920
    s_add_u32 s70, s53, s4
    s_add_u32 m0, s71, 81920
    s_nop 0
    buffer_load_dwordx4 v8, s[16:19], s69 offen offset:0  lds
    buffer_load_dwordx4 v9, s[16:19], s69 offen offset:1024  lds
    s_waitcnt vmcnt(7)
    s_barrier
    buffer_load_dwordx4 v10, s[16:19], s69 offen offset:2048  lds
    buffer_load_dwordx4 v11, s[16:19], s69 offen offset:3072  lds
    s_add_u32 s62, s62, 1
    s_cmp_eq_u32 s62, 3
    s_cselect_b32 s62, 0, s62
    s_lshl_b32 s4, s62, 7
    s_add_u32 s69, s52, s4
    s_add_u32 m0, s59, 0
    s_nop 0
    buffer_load_dwordx4 v18, s[24:27], s70 offen offset:0  lds
    buffer_load_dwordx4 v19, s[24:27], s70 offen offset:1024  lds
    buffer_load_dwordx4 v20, s[24:27], s70 offen offset:2048  lds
    buffer_load_dwordx4 v21, s[24:27], s70 offen offset:3072  lds
    s_add_u32 m0, m0, 4096
    s_nop 0
    buffer_load_dwordx4 v22, s[24:27], s70 offen offset:0  lds
    s_add_u32 s54, s54, 1
    s_cmp_eq_u32 s54, 3
    s_cselect_b32 s54, 0, s54
    s_bfe_u32 s4, s55, 0x20004
    s_add_u32 s4, s4, s40
    s_and_b32 s4, s4, 3
    s_lshl2_add_u32 s53, s39, s4
    s_mul_i32 s53, s53, 245760
    s_add_u32 s53, s53, s58
    s_mul_i32 s4, s54, 81920
    s_add_u32 s70, s53, s4
    s_add_u32 m0, s71, 0
    s_nop 0
    buffer_load_dwordx4 v8, s[16:19], s69 offen offset:0  lds
    buffer_load_dwordx4 v9, s[16:19], s69 offen offset:1024  lds
    s_waitcnt vmcnt(7)
    s_barrier
    s_waitcnt lgkmcnt(0)
    s_add_u32 s46, s28, s51
    s_addc_u32 s47, s29, 0
    s_load_dword s64, s[46:47], 0 glc
    s_load_dword s65, s[46:47], 4096 glc
    s_load_dword s66, s[46:47], 8192 glc
    s_load_dword s67, s[46:47], 12288 glc
    buffer_load_dwordx4 v10, s[16:19], s69 offen offset:2048  lds
    buffer_load_dwordx4 v11, s[16:19], s69 offen offset:3072  lds
    s_add_u32 s62, s62, 1
    s_cmp_eq_u32 s62, 3
    s_cselect_b32 s62, 0, s62
    s_bfe_u32 s4, s55, 0x20004
    s_add_u32 s4, s4, s40
    s_and_b32 s4, s4, 3
    s_lshl2_add_u32 s52, s39, s4
    s_mul_i32 s52, s52, 12288
    s_add_u32 s52, s52, s63
    s_lshl_b32 s4, s62, 7
    s_add_u32 s69, s52, s4
    s_add_u32 m0, s59, 40960
    s_nop 0
    buffer_load_dwordx4 v18, s[24:27], s70 offen offset:0  lds
    buffer_load_dwordx4 v19, s[24:27], s70 offen offset:1024  lds
    buffer_load_dwordx4 v20, s[24:27], s70 offen offset:2048  lds
    buffer_load_dwordx4 v21, s[24:27], s70 offen offset:3072  lds
    s_add_u32 m0, m0, 4096
    s_nop 0
    buffer_load_dwordx4 v22, s[24:27], s70 offen offset:0  lds
    s_add_u32 s54, s54, 1
    s_cmp_eq_u32 s54, 3
    s_cselect_b32 s54, 0, s54
    s_mul_i32 s4, s54, 81920
    s_add_u32 s70, s53, s4
    s_add_u32 m0, s71, 40960
    s_nop 0
    buffer_load_dwordx4 v8, s[16:19], s69 offen offset:0  lds
    buffer_load_dwordx4 v9, s[16:19], s69 offen offset:1024  lds
    s_waitcnt vmcnt(7)
    s_barrier
    s_waitcnt lgkmcnt(0)
    s_mov_b32 s50, 0
    s_cmp_eq_u32 s67, 0
    s_addc_u32 s50, s50, s50
    s_cmp_eq_u32 s66, 0
    s_addc_u32 s50, s50, s50
    s_cmp_eq_u32 s65, 0
    s_addc_u32 s50, s50, s50
    s_cmp_eq_u32 s64, 0
    s_addc_u32 s50, s50, s50
L_pchk1:
    s_add_u32 s4, s40, 1
    s_and_b32 s4, s4, 3
    s_lshl2_add_u32 s73, s39, s4
    s_bitcmp1_b32 s50, s4
    s_cbranch_scc0 L_pslow1
    s_lshl_b32 s73, s73, 13
    s_add_u32 m0, s61, 131072
    s_add_u32 s73, s73, s60
    buffer_load_dwordx4 v23, s[28:31], s73 offen sc1 lds
    buffer_load_dwordx4 v23, s[28:31], s73 offen offset:1024 sc1 lds
    s_add_u32 m0, s71, 40960
    s_nop 0
    buffer_load_dwordx4 v10, s[16:19], s69 offen offset:2048  lds
    buffer_load_dwordx4 v11, s[16:19], s69 offen offset:3072  lds
    s_add_u32 s62, s62, 1
    s_cmp_eq_u32 s62, 3
    s_cselect_b32 s62, 0, s62
    s_lshl_b32 s4, s62, 7
    s_add_u32 s69, s52, s4
L_pchk2:
    s_bfe_u32 s4, s55, 0x20004
    s_add_u32 s4, s4, s40
    s_and_b32 s4, s4, 3
    s_lshl2_add_u32 s73, s39, s4
    s_bitcmp1_b32 s50, s4
    s_cbranch_scc0 L_pslow2
    s_lshl_b32 s73, s73, 13
    s_add_u32 m0, s61, 122880
    s_add_u32 s73, s73, s60
    buffer_load_dwordx4 v23, s[28:31], s73 offen sc1 lds
    buffer_load_dwordx4 v23, s[28:31], s73 offen offset:1024 sc1 lds
    s_add_u32 m0, s59, 81920
    s_nop 0
    buffer_load_dwordx4 v18, s[24:27], s70 offen offset:0  lds
    buffer_load_dwordx4 v19, s[24:27], s70 offen offset:1024  lds
    buffer_load_dwordx4 v20, s[24:27], s70 offen offset:2048  lds
    s_waitcnt vmcnt(5)
    s_barrier
    buffer_load_dwordx4 v21, s[24:27], s70 offen offset:3072  lds
    s_add_u32 m0, m0, 4096
    s_nop 0
    buffer_load_dwordx4 v22, s[24:27], s70 offen offset:0  lds
    s_add_u32 s54, s54, 1
    s_cmp_eq_u32 s54, 3
    s_cselect_b32 s54, 0, s54
    s_mul_i32 s4, s54, 81920
    s_add_u32 s70, s53, s4
    s_add_u32 m0, s71, 81920
    s_nop 0
    buffer_load_dwordx4 v8, s[16:19], s69 offen offset:0  lds
    buffer_load_dwordx4 v9, s[16:19], s69 offen offset:1024  lds
    buffer_load_dwordx4 v10, s[16:19], s69 offen offset:2048  lds
    buffer_load_dwordx4 v11, s[16:19], s69 offen offset:3072  lds
    s_add_u32 s62, s62, 1
    s_cmp_eq_u32 s62, 3
    s_cselect_b32 s62, 0, s62
    s_lshl_b32 s4, s62, 7
    s_add_u32 s69, s52, s4
    s_add_u32 m0, s59, 0
    s_nop 0
    buffer_load_dwordx4 v18, s[24:27], s70 offen offset:0  lds
    buffer_load_dwordx4 v19, s[24:27], s70 offen offset:1024  lds
    buffer_load_dwordx4 v20, s[24:27], s70 offen offset:2048  lds
    buffer_load_dwordx4 v21, s[24:27], s70 offen offset:3072  lds
    s_add_u32 m0, m0, 4096
    s_nop 0
    buffer_load_dwordx4 v22, s[24:27], s70 offen offset:0  lds
    s_add_u32 s54, s54, 1
    s_cmp_eq_u32 s54, 3
    s_cselect_b32 s54, 0, s54
    s_bfe_u32 s4, s55, 0x20006
    s_add_u32 s4, s4, s40
    s_and_b32 s4, s4, 3
    s_lshl2_add_u32 s53, s39, s4
    s_mul_i32 s53, s53, 245760
    s_add_u32 s53, s53, s58
    s_mul_i32 s4, s54, 81920
    s_add_u32 s70, s53, s4
    s_add_u32 m0, s71, 0
    s_nop 0
    buffer_load_dwordx4 v8, s[16:19], s69 offen offset:0  lds
    buffer_load_dwordx4 v9, s[16:19], s69 offen offset:1024  lds
    s_waitcnt vmcnt(7)
    s_barrier
    buffer_load_dwordx4 v10, s[16:19], s69 offen offset:2048  lds
    buffer_load_dwordx4 v11, s[16:19], s69 offen offset:3072  lds
    s_add_u32 s62, s62, 1
    s_cmp_eq_u32 s62, 3
    s_cselect_b32 s62, 0, s62
    s_bfe_u32 s4, s55, 0x20006
    s_add_u32 s4, s4, s40
    s_and_b32 s4, s4, 3
    s_lshl2_add_u32 s52, s39, s4
    s_mul_i32 s52, s52, 12288
    s_add_u32 s52, s52, s63
    s_lshl_b32 s4, s62, 7
    s_add_u32 s69, s52, s4
L_pchk3:
    s_bfe_u32 s4, s55, 0x20006
    s_add_u32 s4, s4, s40
    s_and_b32 s4, s4, 3
    s_lshl2_add_u32 s73, s39, s4
    s_bitcmp1_b32 s50, s4
    s_cbranch_scc0 L_pslow3
    s_lshl_b32 s73, s73, 13
    s_add_u32 m0, s61, 131072
    s_add_u32 s73, s73, s60
    buffer_load_dwordx4 v23, s[28:31], s73 offen sc1 lds
    buffer_load_dwordx4 v23, s[28:31], s73 offen offset:1024 sc1 lds
    s_add_u32 m0, s59, 40960
    s_nop 0
    buffer_load_dwordx4 v18, s[24:27], s70 offen offset:0  lds
    buffer_load_dwordx4 v19, s[24:27], s70 offen offset:1024  lds
    buffer_load_dwordx4 v20, s[24:27], s70 offen offset:2048  lds
    buffer_load_dwordx4 v21, s[24:27], s70 offen offset:3072  lds
    s_add_u32 m0, m0, 4096
    s_nop 0
    buffer_load_dwordx4 v22, s[24:27], s70 offen offset:0  lds
    s_add_u32 s54, s54, 1
    s_cmp_eq_u32 s54, 3
    s_cselect_b32 s54, 0, s54
    s_mul_i32 s4, s54, 81920
    s_add_u32 s70, s53, s4
    s_waitcnt vmcnt(7)
    s_barrier
    s_add_u32 m0, s71, 40960
    s_nop 0
    buffer_load_dwordx4 v8, s[16:19], s69 offen offset:0  lds
    buffer_load_dwordx4 v9, s[16:19], s69 offen offset:1024  lds
    buffer_load_dwordx4 v10, s[16:19], s69 offen offset:2048  lds
    buffer_load_dwordx4 v11, s[16:19], s69 offen offset:3072  lds
    s_add_u32 s62, s62, 1
    s_cmp_eq_u32 s62, 3
    s_cselect_b32 s62, 0, s62
    s_lshl_b32 s4, s62, 7
    s_add_u32 s69, s52, s4
    s_add_u32 m0, s59, 81920
    s_nop 0
    buffer_load_dwordx4 v18, s[24:27], s70 offen offset:0  lds
    buffer_load_dwordx4 v19, s[24:27], s70 offen offset:1024  lds
    buffer_load_dwordx4 v20, s[24:27], s70 offen offset:2048  lds
    buffer_load_dwordx4 v21, s[24:27], s70 offen offset:3072  lds
    s_add_u32 m0, m0, 4096
    s_nop 0
    buffer_load_dwordx4 v22, s[24:27], s70 offen offset:0  lds
    s_add_u32 s54, s54, 1
    s_cmp_eq_u32 s54, 3
    s_cselect_b32 s54, 0, s54
    s_mul_i32 s4, s54, 81920
    s_add_u32 s70, s53, s4
    s_add_u32 m0, s71, 81920
    s_nop 0
    buffer_load_dwordx4 v8, s[16:19], s69 offen offset:0  lds
    buffer_load_dwordx4 v9, s[16:19], s69 offen offset:1024  lds
    buffer_load_dwordx4 v10, s[16:19], s69 offen offset:2048  lds
    buffer_load_dwordx4 v11, s[16:19], s69 offen offset:3072  lds
    s_add_u32 s62, s62, 1
    s_cmp_eq_u32 s62, 3
    s_cselect_b32 s62, 0, s62
    s_lshl_b32 s4, s62, 7
    s_add_u32 s69, s52, s4
    s_waitcnt vmcnt(9)
    s_barrier
    s_add_u32 m0, s59, 0
    s_nop 0
    buffer_load_dwordx4 v18, s[24:27], s70 offen offset:0  lds
    buffer_load_dwordx4 v19, s[24:27], s70 offen offset:1024  lds
    buffer_load_dwordx4 v20, s[24:27], s70 offen offset:2048  lds
    buffer_load_dwordx4 v21, s[24:27], s70 offen offset:3072  lds
    s_add_u32 m0, m0, 4096
    s_nop 0
    buffer_load_dwordx4 v22, s[24:27], s70 offen offset:0  lds
    s_add_u32 m0, s71, 0
    s_nop 0
    buffer_load_dwordx4 v8, s[16:19], s69 offen offset:0  lds
    buffer_load_dwordx4 v9, s[16:19], s69 offen offset:1024  lds
    s_waitcnt vmcnt(7)
    s_barrier
    buffer_load_dwordx4 v10, s[16:19], s69 offen offset:2048  lds
    buffer_load_dwordx4 v11, s[16:19], s69 offen offset:3072  lds
    s_waitcnt vmcnt(0)
    s_barrier
    s_mov_b32 s44, s41
    v_bfrev_b32 v253, 1
    s_mov_b32 s56, 0
L_reduce:
    s_mov_b32 s50, 1310720
    s_mov_b32 s51, 0x00020000
    s_lshl2_add_u32 s4, s42, s40
    s_lshl3_add_u32 s4, s4, s39
    s_lshl_b32 s5, s4, 7
    s_add_u32 s5, s5, 2097152
    v_and_b32 v1, 7, v0
    v_lshlrev_b32 v1, 2, v1
    s_mul_i32 s4, s4, 40960
    s_lshl_b32 s6, s44, 10
    s_add_u32 s4, s4, s6
    s_add_u32 s4, s4, 4194304
    v_lshlrev_b32 v2, 4, v0
    s_add_u32 s6, s6, 139264
    v_add_u32 v7, s6, v2
    s_lshr_b32 s6, s39, 1
    s_lshl2_add_u32 s6, s37, s6
    s_mul_i32 s6, s6, 81920
    s_mul_i32 s7, s36, 1280
    s_add_u32 s6, s6, s7
    s_mul_i32 s7, s40, 320
    s_add_u32 s6, s6, s7
    s_bfe_u32 s7, s39, 0x10000
    s_mul_i32 s7, s7, 160
    s_add_u32 s6, s6, s7
    s_lshl_b32 s7, s44, 5
    s_add_u32 s6, s6, s7
    v_and_b32 v3, 31, v0
    v_mul_u32_u24 v3, 2560, v3
    v_lshrrev_b32 v4, 5, v0
    v_lshl_add_u32 v3, v4, 4, v3
    s_lshl_b32 s45, 1, s39
    s_cmp_lt_u32 s3, 4
    s_cbranch_scc1 L_rnoa
    s_barrier
L_rnoa:
    ds_read_b128 v[96:99], v7
    s_add_u32 s72, s28, s5
    s_addc_u32 s73, s29, 0
    s_mov_b32 s74, 1
    s_waitcnt lgkmcnt(0)
    s_load_dwordx8 s[64:71], s[72:73], 0 glc
    v_lshlrev_b32 v8, 16, v96
    v_and_b32 v9, 0xffff0000, v96
    v_lshlrev_b32 v10, 16, v97
    v_and_b32 v11, 0xffff0000, v97
    v_lshlrev_b32 v12, 16, v98
    v_and_b32 v13, 0xffff0000, v98
    v_lshlrev_b32 v14, 16, v99
    v_and_b32 v15, 0xffff0000, v99
    s_waitcnt vmcnt(1)
    buffer_store_dword v252, v253, s[28:31], s56 offen sc1
    s_branch L_rwait
L_rpoll:
    s_load_dwordx8 s[64:71], s[72:73], 0 glc
L_rwait:
    s_waitcnt lgkmcnt(0)
    s_mov_b32 s46, 0
    s_cmp_eq_u32 s71, 0
    s_addc_u32 s46, s46, s46
    s_cmp_eq_u32 s70, 0
    s_addc_u32 s46, s46, s46
    s_cmp_eq_u32 s69, 0
    s_addc_u32 s46, s46, s46
    s_cmp_eq_u32 s68, 0
    s_addc_u32 s46, s46, s46
    s_cmp_eq_u32 s67, 0
    s_addc_u32 s46, s46, s46
    s_cmp_eq_u32 s66, 0
    s_addc_u32 s46, s46, s46
    s_cmp_eq_u32 s65, 0
    s_addc_u32 s46, s46, s46
    s_cmp_eq_u32 s64, 0
    s_addc_u32 s46, s46, s46
    s_andn2_b32 s47, s46, s45
    s_cbranch_scc0 L_rpoll
L_rgot:
    s_or_b32 s45, s45, s46
    s_cmp_eq_u32 s45, 0xff
    s_cbranch_scc1 L_rall
    s_load_dwordx8 s[64:71], s[72:73], 0 glc
L_rall:
    s_cmp_eq_u32 s74, 2
    s_cbranch_scc1 L_rld2
    s_cmp_eq_u32 s74, 3
    s_cbranch_scc1 L_rld3
    s_cmp_eq_u32 s74, 4
    s_cbranch_scc1 L_rld4
    s_cmp_eq_u32 s74, 5
    s_cbranch_scc1 L_rld5
    s_cmp_eq_u32 s74, 6
    s_cbranch_scc1 L_rld6
    s_cmp_eq_u32 s74, 7
    s_cbranch_scc1 L_rld7
L_rld1:
    s_ff1_i32_b32 s7, s47
    s_bitset0_b32 s47, s7
    s_mul_i32 s7, s7, 5120
    s_add_u32 s7, s7, s4
    buffer_load_dwordx4 v[20:23], v2, s[28:31], s7 offen sc1
    s_mov_b32 s74, 2
    s_cmp_eq_u32 s47, 0
    s_cbranch_scc1 L_rwait
L_rld2:
    s_ff1_i32_b32 s7, s47
    s_bitset0_b32 s47, s7
    s_mul_i32 s7, s7, 5120
    s_add_u32 s7, s7, s4
    buffer_load_dwordx4 v[24:27], v2, s[28:31], s7 offen sc1
    s_mov_b32 s74, 3
    s_cmp_eq_u32 s47, 0
    s_cbranch_scc1 L_rwait
L_rld3:
    s_ff1_i32_b32 s7, s47
    s_bitset0_b32 s47, s7
    s_mul_i32 s7, s7, 5120
    s_add_u32 s7, s7, s4
    buffer_load_dwordx4 v[28:31], v2, s[28:31], s7 offen sc1
    s_mov_b32 s74, 4
    s_cmp_eq_u32 s47, 0
    s_cbranch_scc1 L_rwait
L_rld4:
    s_ff1_i32_b32 s7, s47
    s_bitset0_b32 s47, s7
    s_mul_i32 s7, s7, 5120
    s_add_u32 s7, s7, s4
    buffer_load_dwordx4 v[32:35], v2, s[28:31], s7 offen sc1
    s_mov_b32 s74, 5
    s_cmp_eq_u32 s47, 0
    s_cbranch_scc1 L_rwait
L_rld5:
    s_ff1_i32_b32 s7, s47
    s_bitset0_b32 s47, s7
    s_mul_i32 s7, s7, 5120
    s_add_u32 s7, s7, s4
    buffer_load_dwordx4 v[36:39], v2, s[28:31], s7 offen sc1
    s_mov_b32 s74, 6
    s_cmp_eq_u32 s47, 0
    s_cbranch_scc1 L_rwait
L_rld6:
    s_ff1_i32_b32 s7, s47
    s_bitset0_b32 s47, s7
    s_mul_i32 s7, s7, 5120
    s_add_u32 s7, s7, s4
    buffer_load_dwordx4 v[40:43], v2, s[28:31], s7 offen sc1
    s_mov_b32 s74, 7
    s_cmp_eq_u32 s47, 0
    s_cbranch_scc1 L_rwait
L_rld7:
    s_ff1_i32_b32 s7, s47
    s_bitset0_b32 s47, s7
    s_mul_i32 s7, s7, 5120
    s_add_u32 s7, s7, s4
    buffer_load_dwordx4 v[44:47], v2, s[28:31], s7 offen sc1
    s_waitcnt vmcnt(6)
    v_lshlrev_b32 v5, 16, v20
    v_and_b32 v6, 0xffff0000, v20
    v_add_f32 v8, v8, v5
    v_add_f32 v9, v9, v6
    v_lshlrev_b32 v5, 16, v21
    v_and_b32 v6, 0xffff0000, v21
    v_add_f32 v10, v10, v5
    v_add_f32 v11, v11, v6
    v_lshlrev_b32 v5, 16, v22
    v_and_b32 v6, 0xffff0000, v22
    v_add_f32 v12, v12, v5
    v_add_f32 v13, v13, v6
    v_lshlrev_b32 v5, 16, v23
    v_and_b32 v6, 0xffff0000, v23
    v_add_f32 v14, v14, v5
    v_add_f32 v15, v15, v6
    s_waitcnt vmcnt(5)
    v_lshlrev_b32 v5, 16, v24
    v_and_b32 v6, 0xffff0000, v24
    v_add_f32 v8, v8, v5
    v_add_f32 v9, v9, v6
    v_lshlrev_b32 v5, 16, v25
    v_and_b32 v6, 0xffff0000, v25
    v_add_f32 v10, v10, v5
    v_add_f32 v11, v11, v6
    v_lshlrev_b32 v5, 16, v26
    v_and_b32 v6, 0xffff0000, v26
    v_add_f32 v12, v12, v5
    v_add_f32 v13, v13, v6
    v_lshlrev_b32 v5, 16, v27
    v_and_b32 v6, 0xffff0000, v27
    v_add_f32 v14, v14, v5
    v_add_f32 v15, v15, v6
    s_waitcnt vmcnt(4)
    v_lshlrev_b32 v5, 16, v28
    v_and_b32 v6, 0xffff0000, v28
    v_add_f32 v8, v8, v5
    v_add_f32 v9, v9, v6
    v_lshlrev_b32 v5, 16, v29
    v_and_b32 v6, 0xffff0000, v29
    v_add_f32 v10, v10, v5
    v_add_f32 v11, v11, v6
    v_lshlrev_b32 v5, 16, v30
    v_and_b32 v6, 0xffff0000, v30
    v_add_f32 v12, v12, v5
    v_add_f32 v13, v13, v6
    v_lshlrev_b32 v5, 16, v31
    v_and_b32 v6, 0xffff0000, v31
    v_add_f32 v14, v14, v5
    v_add_f32 v15, v15, v6
    s_waitcnt vmcnt(3)
    v_lshlrev_b32 v5, 16, v32
    v_and_b32 v6, 0xffff0000, v32
    v_add_f32 v8, v8, v5
    v_add_f32 v9, v9, v6
    v_lshlrev_b32 v5, 16, v33
    v_and_b32 v6, 0xffff0000, v33
    v_add_f32 v10, v10, v5
    v_add_f32 v11, v11, v6
    v_lshlrev_b32 v5, 16, v34
    v_and_b32 v6, 0xffff0000, v34
    v_add_f32 v12, v12, v5
    v_add_f32 v13, v13, v6
    v_lshlrev_b32 v5, 16, v35
    v_and_b32 v6, 0xffff0000, v35
    v_add_f32 v14, v14, v5
    v_add_f32 v15, v15, v6
    s_waitcnt vmcnt(2)
    v_lshlrev_b32 v5, 16, v36
    v_and_b32 v6, 0xffff0000, v36
    v_add_f32 v8, v8, v5
    v_add_f32 v9, v9, v6
    v_lshlrev_b32 v5, 16, v37
    v_and_b32 v6, 0xffff0000, v37
    v_add_f32 v10, v10, v5
    v_add_f32 v11, v11, v6
    v_lshlrev_b32 v5, 16, v38
    v_and_b32 v6, 0xffff0000, v38
    v_add_f32 v12, v12, v5
    v_add_f32 v13, v13, v6
    v_lshlrev_b32 v5, 16, v39
    v_and_b32 v6, 0xffff0000, v39
    v_add_f32 v14, v14, v5
    v_add_f32 v15, v15, v6
    s_waitcnt vmcnt(1)
    v_lshlrev_b32 v5, 16, v40
    v_and_b32 v6, 0xffff0000, v40
    v_add_f32 v8, v8, v5
    v_add_f32 v9, v9, v6
    v_lshlrev_b32 v5, 16, v41
    v_and_b32 v6, 0xffff0000, v41
    v_add_f32 v10, v10, v5
    v_add_f32 v11, v11, v6
    v_lshlrev_b32 v5, 16, v42
    v_and_b32 v6, 0xffff0000, v42
    v_add_f32 v12, v12, v5
    v_add_f32 v13, v13, v6
    v_lshlrev_b32 v5, 16, v43
    v_and_b32 v6, 0xffff0000, v43
    v_add_f32 v14, v14, v5
    v_add_f32 v15, v15, v6
    s_waitcnt vmcnt(0)
    v_lshlrev_b32 v5, 16, v44
    v_and_b32 v6, 0xffff0000, v44
    v_add_f32 v8, v8, v5
    v_add_f32 v9, v9, v6
    v_lshlrev_b32 v5, 16, v45
    v_and_b32 v6, 0xffff0000, v45
    v_add_f32 v10, v10, v5
    v_add_f32 v11, v11, v6
    v_lshlrev_b32 v5, 16, v46
    v_and_b32 v6, 0xffff0000, v46
    v_add_f32 v12, v12, v5
    v_add_f32 v13, v13, v6
    v_lshlrev_b32 v5, 16, v47
    v_and_b32 v6, 0xffff0000, v47
    v_add_f32 v14, v14, v5
    v_add_f32 v15, v15, v6
    v_cvt_pk_bf16_f32 v16, v8, v9
    v_cvt_pk_bf16_f32 v17, v10, v11
    v_cvt_pk_bf16_f32 v18, v12, v13
    v_cvt_pk_bf16_f32 v19, v14, v15
    s_nop 0
    v_permlane16_swap_b32 v16, v18
    v_permlane16_swap_b32 v17, v19
    s_nop 0
    buffer_store_dwordx4 v[16:19], v3, s[48:51], s6 offen
L_end:
    s_endpgm
L_ld1_k:
    s_add_u32 m0, s74, s46
    s_nop 0
    buffer_load_dwordx4 v12, s[20:23], s70 offen offset:0  lds
    buffer_load_dwordx4 v13, s[20:23], s70 offen offset:1024  lds
    buffer_load_dwordx4 v14, s[20:23], s70 offen offset:2048  lds
    s_add_u32 m0, m0, 12288
    s_nop 0
    buffer_load_dwordx4 v15, s[20:23], s70 offen offset:0  lds
    buffer_load_dwordx4 v16, s[20:23], s70 offen offset:1024  lds
    buffer_load_dwordx4 v17, s[20:23], s70 offen offset:2048  lds
    s_cmp_lt_u32 s47, 4
    s_cbranch_scc1 L_nosb2
    s_cmp_eq_u32 s67, 0
    s_cbranch_scc1 L_nosb2
    s_load_dword s66, s[64:65], 0
    s_load_dword s66, s[64:65], 64
    s_load_dword s66, s[64:65], 384
    s_load_dword s66, s[64:65], 448
    s_cmp_eq_u32 s67, 4
    s_cselect_b32 s67, 0, s67
    s_cbranch_scc1 L_nosb2
    s_load_dword s66, s[64:65], 768
    s_load_dword s66, s[64:65], 832
    s_load_dword s66, s[64:65], 1152
    s_load_dword s66, s[64:65], 1216
    s_load_dword s66, s[64:65], 1536
    s_load_dword s66, s[64:65], 1600
    s_load_dword s66, s[64:65], 1920
    s_load_dword s66, s[64:65], 1984
    s_add_u32 s64, s64, 2304
    s_addc_u32 s65, s65, 0
    s_sub_u32 s67, s67, 12
L_nosb2:
    s_add_u32 m0, s71, s46
    s_nop 0
    buffer_load_dwordx4 v4, s[8:11], s69 offen offset:0  lds
    buffer_load_dwordx4 v5, s[8:11], s69 offen offset:1024  lds
    buffer_load_dwordx4 v6, s[8:11], s69 offen offset:2048  lds
    buffer_load_dwordx4 v7, s[8:11], s69 offen offset:3072  lds
    s_lshr_b32 s5, s71, 1
    s_add_u32 m0, s5, 122880
    s_add_u32 s4, s6, 0
    buffer_load_dwordx4 v8, s[12:15], s4 offen offset:0 nt lds
    buffer_load_dwordx4 v9, s[12:15], s4 offen offset:1024 nt lds
    s_add_u32 m0, s5, 131072
    s_add_u32 s4, s6, 128
    buffer_load_dwordx4 v8, s[12:15], s4 offen offset:0 nt lds
    buffer_load_dwordx4 v9, s[12:15], s4 offen offset:1024 nt lds
    s_add_u32 m0, s5, 139264
    s_add_u32 s4, s6, 256
    buffer_load_dwordx4 v8, s[12:15], s4 offen offset:0 nt lds
    buffer_load_dwordx4 v9, s[12:15], s4 offen offset:1024 nt lds
    s_add_u32 s6, s6, 6144
    s_lshr_b32 s7, s7, 4
    s_waitcnt vmcnt(16)
    s_barrier
    s_add_u32 s47, s47, 1
    s_add_u32 s46, s46, 40960
    s_cmp_ge_u32 s46, 122880
    s_cselect_b32 s46, 0, s46
    s_and_b32 s68, s72, 15
    s_add_u32 s68, s68, s75
    s_cmp_ge_u32 s68, 10
    s_cselect_b32 s4, 10, 0
    s_sub_u32 s68, s68, s4
    s_lshl_b32 s69, s68, 7
    s_add_u32 s69, s69, s44
    s_mul_i32 s70, s68, 786432
    s_lshr_b64 s[72:73], s[72:73], 4
    s_add_u32 s70, s70, s45
    s_add_u32 m0, s74, s46
    s_nop 0
    buffer_load_dwordx4 v12, s[20:23], s70 offen offset:0  lds
    buffer_load_dwordx4 v13, s[20:23], s70 offen offset:1024  lds
    s_cmp_lt_u32 s47, 4
    s_cbranch_scc1 L_nosb3
    s_cmp_eq_u32 s67, 0
    s_cbranch_scc1 L_nosb3
    s_load_dword s66, s[64:65], 0
    s_load_dword s66, s[64:65], 64
    s_load_dword s66, s[64:65], 384
    s_load_dword s66, s[64:65], 448
    s_cmp_eq_u32 s67, 4
    s_cselect_b32 s67, 0, s67
    s_cbranch_scc1 L_nosb3
    s_load_dword s66, s[64:65], 768
    s_load_dword s66, s[64:65], 832
    s_load_dword s66, s[64:65], 1152
    s_load_dword s66, s[64:65], 1216
    s_load_dword s66, s[64:65], 1536
    s_load_dword s66, s[64:65], 1600
    s_load_dword s66, s[64:65], 1920
    s_load_dword s66, s[64:65], 1984
    s_add_u32 s64, s64, 2304
    s_addc_u32 s65, s65, 0
    s_sub_u32 s67, s67, 12
L_nosb3:
    s_waitcnt vmcnt(8)
    s_barrier
    buffer_load_dwordx4 v14, s[20:23], s70 offen offset:2048  lds
    s_add_u32 m0, m0, 12288
    s_nop 0
    buffer_load_dwordx4 v15, s[20:23], s70 offen offset:0  lds
    buffer_load_dwordx4 v16, s[20:23], s70 offen offset:1024  lds
    buffer_load_dwordx4 v17, s[20:23], s70 offen offset:2048  lds
    s_add_u32 m0, s71, s46
    s_nop 0
    buffer_load_dwordx4 v4, s[8:11], s69 offen offset:0  lds
    buffer_load_dwordx4 v5, s[8:11], s69 offen offset:1024  lds
    buffer_load_dwordx4 v6, s[8:11], s69 offen offset:2048  lds
    buffer_load_dwordx4 v7, s[8:11], s69 offen offset:3072  lds
    s_branch L_ld1_end
L_mark_spin:
    buffer_load_dword v28, off, s[32:35], s7 sc1
    s_waitcnt vmcnt(0)
    s_branch L_mark_chk
L_pslow1:
    s_load_dword s64, s[46:47], 0 glc
    s_load_dword s65, s[46:47], 4096 glc
    s_load_dword s66, s[46:47], 8192 glc
    s_load_dword s67, s[46:47], 12288 glc
    s_waitcnt lgkmcnt(0)
    s_mov_b32 s50, 0
    s_cmp_eq_u32 s67, 0
    s_addc_u32 s50, s50, s50
    s_cmp_eq_u32 s66, 0
    s_addc_u32 s50, s50, s50
    s_cmp_eq_u32 s65, 0
    s_addc_u32 s50, s50, s50
    s_cmp_eq_u32 s64, 0
    s_addc_u32 s50, s50, s50
    s_branch L_pchk1
L_pslow2:
    s_load_dword s64, s[46:47], 0 glc
    s_load_dword s65, s[46:47], 4096 glc
    s_load_dword s66, s[46:47], 8192 glc
    s_load_dword s67, s[46:47], 12288 glc
    s_waitcnt lgkmcnt(0)
    s_mov_b32 s50, 0
    s_cmp_eq_u32 s67, 0
    s_addc_u32 s50, s50, s50
    s_cmp_eq_u32 s66, 0
    s_addc_u32 s50, s50, s50
    s_cmp_eq_u32 s65, 0
    s_addc_u32 s50, s50, s50
    s_cmp_eq_u32 s64, 0
    s_addc_u32 s50, s50, s50
    s_branch L_pchk2
L_pslow3:
    s_load_dword s64, s[46:47], 0 glc
    s_load_dword s65, s[46:47], 4096 glc
    s_load_dword s66, s[46:47], 8192 glc
    s_load_dword s67, s[46:47], 12288 glc
    s_waitcnt lgkmcnt(0)
    s_mov_b32 s50, 0
    s_cmp_eq_u32 s67, 0
    s_addc_u32 s50, s50, s50
    s_cmp_eq_u32 s66, 0
    s_addc_u32 s50, s50, s50
    s_cmp_eq_u32 s65, 0
    s_addc_u32 s50, s50, s50
    s_cmp_eq_u32 s64, 0
    s_addc_u32 s50, s50, s50
    s_branch L_pchk3
L_consumer:
    s_load_dwordx2 s[28:29], s[0:1], 96
    s_load_dwordx2 s[32:33], s[0:1], 88
    s_load_dwordx2 s[48:49], s[0:1], 80
    s_lshr_b32 s39, s38, 2
    s_and_b32 s40, s38, 3
    s_lshl2_add_u32 s42, s36, s37
    v_and_b32 v252, 15, v0
    v_lshrrev_b32 v253, 4, v0
    v_bfe_u32 v254, v0, 1, 3
    v_xor_b32 v254, v254, v253
    v_lshlrev_b32 v254, 4, v254
    v_lshl_add_u32 v254, v252, 7, v254
    s_lshl_b32 s4, s41, 12
    v_add_u32 v1, s4, v254
    v_xor_b32 v2, 64, v1
    s_and_b32 s4, s41, 2
    s_lshl_b32 s4, s4, 12
    v_add_u32 v244, s4, v254
    v_xor_b32 v245, 64, v244
    v_lshrrev_b32 v255, 5, v0
    v_xor_b32 v255, v255, v253
    v_lshlrev_b32 v255, 4, v255
    v_xor_b32 v255, v255, v254
    v_and_b32 v112, 1, v253
    v_lshl_add_u32 v112, v112, 3, v255
    s_lshl_b32 s4, s41, 11
    s_add_u32 s4, s4, 122880
    v_add_u32 v112, s4, v112
    s_and_b32 s7, s41, 1
    s_lshl_b32 s4, s7, 6
    v_xor_b32 v112, s4, v112
    v_xor_b32 v113, 32, v112
    v_xor_b32 v114, 64, v112
    v_xor_b32 v115, 96, v112
    s_lshl_b32 s5, s7, 13
    v_add_u32 v112, s5, v112
    v_xor_b32 v176, 2048, v112
    v_add_u32 v113, s5, v113
    v_xor_b32 v177, 2048, v113
    s_lshl_b32 s5, s5, 1
    v_add_u32 v114, s5, v114
    v_xor_b32 v178, 2048, v114
    v_add_u32 v115, s5, v115
    v_xor_b32 v179, 2048, v115
    v_bfe_u32 v252, v0, 2, 2
    v_and_b32 v254, 3, v0
    v_lshlrev_b32 v254, 3, v254
    v_add_u32 v254, 16384, v254
    v_mul_u32_u24 v255, 3072, v253
    v_lshl_add_u32 v255, v252, 7, v255
    v_add_u32 v255, v255, v254
    v_bfe_u32 v5, v0, 3, 2
    v_lshlrev_b32 v5, 5, v5
    v_xor_b32 v5, s4, v5
    v_xor_b32 v6, 32, v5
    v_xor_b32 v7, 64, v5
    v_xor_b32 v8, 96, v5
    s_lshl_b32 s5, s7, 10
    v_add3_u32 v5, v5, v255, s5
    v_add3_u32 v6, v6, v255, s5
    s_lshl_b32 s5, s5, 1
    v_add3_u32 v7, v7, v255, s5
    v_add3_u32 v8, v8, v255, s5
    v_lshl_add_u32 v252, v253, 3, v252
    v_mul_u32_u24 v255, 320, v252
    v_add_u32 v255, v255, v254
    s_and_b32 s4, s41, 1
    s_mul_i32 s5, s4, 160
    v_add_u32 v255, s5, v255
    v_and_b32 v253, 1, v253
    v_lshlrev_b32 v253, 5, v253
    s_cmp_eq_u32 s4, 0
    s_cselect_b32 s4, 1, -1
    v_mul_i32_i24 v253, s4, v253
    v_add_u32 v248, v255, v253
    v_sub_u32 v249, v255, v253
    v_add_u32 v3, 81920, v1
    v_add_u32 v4, 81920, v2
    v_add_u32 v9, 81920, v5
    v_add_u32 v10, 81920, v6
    v_add_u32 v11, 81920, v7
    v_add_u32 v12, 81920, v8
    v_add_u32 v246, 81920, v244
    v_add_u32 v247, 81920, v245
    v_add_u32 v250, 81920, v248
    v_add_u32 v251, 81920, v249
    v_xor_b32 v172, 4096, v1
    v_xor_b32 v173, 4096, v2
    v_xor_b32 v174, 4096, v3
    v_xor_b32 v175, 4096, v4
    s_lshl_b32 s64, s41, 12
    s_add_u32 s64, s64, 147456
    s_lshl_b32 s4, s42, 5
    s_add_u32 s4, s4, s38
    s_lshl2_add_u32 s4, s4, s41
    s_lshl_b32 s69, s4, 11
    v_lshlrev_b32 v13, 4, v0
    v_mov_b32 v228, -1
    v_mov_b32 v229, -1
    v_mov_b32 v230, -1
    v_mov_b32 v231, -1
    s_mov_b32 s30, 268435456
    s_mov_b32 s31, 0x00020000
    s_and_b32 s4, s41, 2
    s_lshl_b32 s4, s4, 11
    s_add_u32 s4, s4, 122880
    v_add_u32 v14, s4, v13
    s_lshl2_add_u32 s4, s42, s40
    s_lshl3_add_u32 s4, s4, s39
    s_lshl_b32 s73, s4, 7
    s_add_u32 s73, s73, 2097152
    s_lshl2_add_u32 s66, s4, s41
    s_lshl_b32 s66, s66, 7
    s_add_u32 s66, s66, 3145728
    s_lshl_b32 s4, s37, 3
    s_lshr_b32 s4, 0x73958484, s4
    s_and_b32 s5, s4, 15
    s_lshl_b32 s74, 1, s5
    s_bfe_u32 s5, s4, 0x40004
    s_lshl_b32 s75, 1, s5
    s_lshl_b32 s4, s37, 2
    s_lshr_b32 s4, 0x211, s4
    s_and_b32 s67, s4, 15
    s_cmp_eq_u32 s41, 0
    s_cselect_b32 s67, s67, 15
    s_lshl_b32 s70, 1, s67
    s_or_b32 s70, s70, s74
    s_or_b32 s70, s70, s75
    s_bitset1_b32 s70, 0
    s_mov_b32 s71, 0
    s_mov_b32 s72, 0x3dd53b95
    v_mov_b32 v252, 1
    s_mov_b32 s34, 256
    s_mov_b32 s35, 0x00020000
    s_lshl_b32 s68, s42, 5
    s_waitcnt lgkmcnt(0)
    s_cmp_lg_u32 s41, 0
    s_cbranch_scc1 L_nomark
    s_add_u32 s4, s69, 4096
    s_mov_b64 exec, 0xff
    buffer_store_dwordx4 v[228:231], v13, s[28:31], s73 offen sc1
    s_mov_b32 exec_lo, 0xffffffff
    buffer_store_dwordx4 v[228:231], v13, s[28:31], s66 offen sc1
    s_mov_b64 exec, -1
L_nomark:
    s_cmp_lg_u32 s41, 1
    s_cbranch_scc1 L_nopf
    s_getpc_b64 s[4:5]
L_pc:
    s_sub_u32 s4, s4, L_pc-concat_heads__gqa_block_cached__gqa_block_cached__near_ridge_kernel
    s_subb_u32 s5, s5, 0
    s_bfe_u32 s6, s2, 0x30003
    v_lshlrev_b32 v253, 3, v0
    v_add_lshl_u32 v253, v253, s6, 7
    v_min_u32 v253, L_codeend-concat_heads__gqa_block_cached__gqa_block_cached__near_ridge_kernel-4, v253
    v_mov_b32 v255, s5
    v_add_co_u32 v254, vcc, s4, v253
    v_addc_co_u32 v255, vcc, 0, v255, vcc
    global_load_dword v253, v[254:255], off
L_nopf:
    v_mov_b32 v16, 0
    v_mov_b32 v17, 0
    v_mov_b32 v18, 0
    v_mov_b32 v19, 0
    v_mov_b32 v20, 0
    v_mov_b32 v21, 0
    v_mov_b32 v22, 0
    v_mov_b32 v23, 0
    v_mov_b32 v24, 0
    v_mov_b32 v25, 0
    v_mov_b32 v26, 0
    v_mov_b32 v27, 0
    v_mov_b32 v28, 0
    v_mov_b32 v29, 0
    v_mov_b32 v30, 0
    v_mov_b32 v31, 0
    v_mov_b32 v32, 0
    v_mov_b32 v33, 0
    v_mov_b32 v34, 0
    v_mov_b32 v35, 0
    v_mov_b32 v36, 0
    v_mov_b32 v37, 0
    v_mov_b32 v38, 0
    v_mov_b32 v39, 0
    v_mov_b32 v40, 0
    v_mov_b32 v41, 0
    v_mov_b32 v42, 0
    v_mov_b32 v43, 0
    v_mov_b32 v44, 0
    v_mov_b32 v45, 0
    v_mov_b32 v46, 0
    v_mov_b32 v47, 0
    v_mov_b32 v48, 0
    v_mov_b32 v49, 0
    v_mov_b32 v50, 0
    v_mov_b32 v51, 0
    v_mov_b32 v52, 0
    v_mov_b32 v53, 0
    v_mov_b32 v54, 0
    v_mov_b32 v55, 0
    v_mov_b32 v56, 0
    v_mov_b32 v57, 0
    v_mov_b32 v58, 0
    v_mov_b32 v59, 0
    v_mov_b32 v60, 0
    v_mov_b32 v61, 0
    v_mov_b32 v62, 0
    v_mov_b32 v63, 0
    v_mov_b32 v64, 0
    v_mov_b32 v65, 0
    v_mov_b32 v66, 0
    v_mov_b32 v67, 0
    v_mov_b32 v68, 0
    v_mov_b32 v69, 0
    v_mov_b32 v70, 0
    v_mov_b32 v71, 0
    v_mov_b32 v72, 0
    v_mov_b32 v73, 0
    v_mov_b32 v74, 0
    v_mov_b32 v75, 0
    v_mov_b32 v76, 0
    v_mov_b32 v77, 0
    v_mov_b32 v78, 0
    v_mov_b32 v79, 0
    v_mov_b32 v80, 0
    v_mov_b32 v81, 0
    v_mov_b32 v82, 0
    v_mov_b32 v83, 0
    v_mov_b32 v84, 0
    v_mov_b32 v85, 0
    v_mov_b32 v86, 0
    v_mov_b32 v87, 0
    v_mov_b32 v88, 0
    v_mov_b32 v89, 0
    v_mov_b32 v90, 0
    v_mov_b32 v91, 0
    v_mov_b32 v92, 0
    v_mov_b32 v93, 0
    v_mov_b32 v94, 0
    v_mov_b32 v95, 0
    v_mov_b32 v96, 0
    v_mov_b32 v97, 0
    v_mov_b32 v98, 0
    v_mov_b32 v99, 0
    v_mov_b32 v100, 0
    v_mov_b32 v101, 0
    v_mov_b32 v102, 0
    v_mov_b32 v103, 0
    v_mov_b32 v104, 0
    v_mov_b32 v105, 0
    v_mov_b32 v106, 0
    v_mov_b32 v107, 0
    v_mov_b32 v108, 0
    v_mov_b32 v109, 0
    v_mov_b32 v110, 0
    v_mov_b32 v111, 0
    s_barrier
    ds_read_b128 v[140:143], v1 offset:0
    ds_read_b128 v[144:147], v1 offset:2048
    ds_read_b128 v[148:151], v172 offset:0
    ds_read_b128 v[152:155], v172 offset:2048
    ds_read_b64_tr_b16 v[116:117], v5 offset:0
    ds_read_b64_tr_b16 v[118:119], v5 offset:512
    ds_read_b64_tr_b16 v[120:121], v6 offset:0
    ds_read_b64_tr_b16 v[122:123], v6 offset:512
    ds_read_b64_tr_b16 v[124:125], v7 offset:0
    ds_read_b64_tr_b16 v[126:127], v7 offset:512
    ds_read_b64_tr_b16 v[128:129], v8 offset:0
    ds_read_b64_tr_b16 v[130:131], v8 offset:512
    ds_read_b64_tr_b16 v[132:133], v5 offset:1024
    ds_read_b64_tr_b16 v[134:135], v5 offset:1536
    ds_read_b64_tr_b16 v[136:137], v6 offset:1024
    ds_read_b64_tr_b16 v[138:139], v6 offset:1536
L_p1:
    s_waitcnt lgkmcnt(6)
    v_mfma_f32_16x16x32_bf16 v[16:19], v[116:119], v[140:143], v[16:19]
    ds_read_b128 v[156:159], v2 offset:0
    v_mfma_f32_16x16x32_bf16 v[20:23], v[116:119], v[144:147], v[20:23]
    ds_read_b128 v[160:163], v2 offset:2048
    v_mfma_f32_16x16x32_bf16 v[24:27], v[116:119], v[148:151], v[24:27]
    ds_read_b128 v[164:167], v173 offset:0
    v_mfma_f32_16x16x32_bf16 v[28:31], v[116:119], v[152:155], v[28:31]
    ds_read_b64_tr_b16 v[116:117], v5 offset:12288
    v_mfma_f32_16x16x32_bf16 v[44:47], v[120:123], v[152:155], v[44:47]
    ds_read_b64_tr_b16 v[118:119], v5 offset:12800
    v_mfma_f32_16x16x32_bf16 v[40:43], v[120:123], v[148:151], v[40:43]
    ds_read_b128 v[168:171], v173 offset:2048
    v_mfma_f32_16x16x32_bf16 v[36:39], v[120:123], v[144:147], v[36:39]
    s_waitcnt lgkmcnt(6)
    v_mfma_f32_16x16x32_bf16 v[32:35], v[120:123], v[140:143], v[32:35]
    ds_read_b64_tr_b16 v[120:121], v6 offset:12288
    v_mfma_f32_16x16x32_bf16 v[48:51], v[124:127], v[140:143], v[48:51]
    ds_read_b64_tr_b16 v[122:123], v6 offset:12800
    v_mfma_f32_16x16x32_bf16 v[52:55], v[124:127], v[144:147], v[52:55]
    v_mfma_f32_16x16x32_bf16 v[56:59], v[124:127], v[148:151], v[56:59]
    v_mfma_f32_16x16x32_bf16 v[60:63], v[124:127], v[152:155], v[60:63]
    ds_read_b64_tr_b16 v[124:125], v7 offset:12288
    v_mfma_f32_16x16x32_bf16 v[76:79], v[128:131], v[152:155], v[76:79]
    ds_read_b64_tr_b16 v[126:127], v7 offset:12800
    v_mfma_f32_16x16x32_bf16 v[72:75], v[128:131], v[148:151], v[72:75]
    v_mfma_f32_16x16x32_bf16 v[68:71], v[128:131], v[144:147], v[68:71]
    v_mfma_f32_16x16x32_bf16 v[64:67], v[128:131], v[140:143], v[64:67]
    ds_read_b64_tr_b16 v[128:129], v8 offset:12288
    v_mfma_f32_16x16x32_bf16 v[80:83], v[132:135], v[140:143], v[80:83]
    ds_read_b64_tr_b16 v[130:131], v8 offset:12800
    v_mfma_f32_16x16x32_bf16 v[84:87], v[132:135], v[144:147], v[84:87]
    v_mfma_f32_16x16x32_bf16 v[88:91], v[132:135], v[148:151], v[88:91]
    v_mfma_f32_16x16x32_bf16 v[92:95], v[132:135], v[152:155], v[92:95]
    ds_read_b64_tr_b16 v[132:133], v5 offset:13312
    v_mfma_f32_16x16x32_bf16 v[108:111], v[136:139], v[152:155], v[108:111]
    ds_read_b64_tr_b16 v[134:135], v5 offset:13824
    v_mfma_f32_16x16x32_bf16 v[104:107], v[136:139], v[148:151], v[104:107]
    s_bitcmp1_b32 s70, 0
    v_mfma_f32_16x16x32_bf16 v[100:103], v[136:139], v[144:147], v[100:103]
    v_mfma_f32_16x16x32_bf16 v[96:99], v[136:139], v[140:143], v[96:99]
    ds_read_b64_tr_b16 v[136:137], v6 offset:13312
    ds_read_b64_tr_b16 v[138:139], v6 offset:13824
    s_cbranch_scc1 L_ev0
L_evback0:
    s_waitcnt lgkmcnt(4)
    v_mfma_f32_16x16x32_bf16 v[16:19], v[116:119], v[156:159], v[16:19]
    v_mfma_f32_16x16x32_bf16 v[20:23], v[116:119], v[160:163], v[20:23]
    v_mfma_f32_16x16x32_bf16 v[24:27], v[116:119], v[164:167], v[24:27]
    v_mfma_f32_16x16x32_bf16 v[28:31], v[116:119], v[168:171], v[28:31]
    v_mfma_f32_16x16x32_bf16 v[44:47], v[120:123], v[168:171], v[44:47]
    v_mfma_f32_16x16x32_bf16 v[40:43], v[120:123], v[164:167], v[40:43]
    s_waitcnt lgkmcnt(0)
    s_barrier
    v_mfma_f32_16x16x32_bf16 v[36:39], v[120:123], v[160:163], v[36:39]
    ds_read_b128 v[140:143], v1 offset:40960
    v_mfma_f32_16x16x32_bf16 v[32:35], v[120:123], v[156:159], v[32:35]
    ds_read_b128 v[144:147], v1 offset:43008
    v_mfma_f32_16x16x32_bf16 v[48:51], v[124:127], v[156:159], v[48:51]
    ds_read_b128 v[148:151], v172 offset:40960
    ds_read_b128 v[152:155], v172 offset:43008
    v_mfma_f32_16x16x32_bf16 v[52:55], v[124:127], v[160:163], v[52:55]
    ds_read_b64_tr_b16 v[116:117], v5 offset:40960
    ds_read_b64_tr_b16 v[118:119], v5 offset:41472
    v_mfma_f32_16x16x32_bf16 v[56:59], v[124:127], v[164:167], v[56:59]
    ds_read_b64_tr_b16 v[120:121], v6 offset:40960
    ds_read_b64_tr_b16 v[122:123], v6 offset:41472
    v_mfma_f32_16x16x32_bf16 v[60:63], v[124:127], v[168:171], v[60:63]
    ds_read_b64_tr_b16 v[124:125], v7 offset:40960
    v_mfma_f32_16x16x32_bf16 v[76:79], v[128:131], v[168:171], v[76:79]
    ds_read_b64_tr_b16 v[126:127], v7 offset:41472
    v_mfma_f32_16x16x32_bf16 v[72:75], v[128:131], v[164:167], v[72:75]
    v_mfma_f32_16x16x32_bf16 v[68:71], v[128:131], v[160:163], v[68:71]
    v_mfma_f32_16x16x32_bf16 v[64:67], v[128:131], v[156:159], v[64:67]
    ds_read_b64_tr_b16 v[128:129], v8 offset:40960
    v_mfma_f32_16x16x32_bf16 v[80:83], v[132:135], v[156:159], v[80:83]
    ds_read_b64_tr_b16 v[130:131], v8 offset:41472
    v_mfma_f32_16x16x32_bf16 v[84:87], v[132:135], v[160:163], v[84:87]
    v_mfma_f32_16x16x32_bf16 v[88:91], v[132:135], v[164:167], v[88:91]
    v_mfma_f32_16x16x32_bf16 v[92:95], v[132:135], v[168:171], v[92:95]
    ds_read_b64_tr_b16 v[132:133], v5 offset:41984
    v_mfma_f32_16x16x32_bf16 v[108:111], v[136:139], v[168:171], v[108:111]
    ds_read_b64_tr_b16 v[134:135], v5 offset:42496
    v_mfma_f32_16x16x32_bf16 v[104:107], v[136:139], v[164:167], v[104:107]
    v_mfma_f32_16x16x32_bf16 v[100:103], v[136:139], v[160:163], v[100:103]
    v_mfma_f32_16x16x32_bf16 v[96:99], v[136:139], v[156:159], v[96:99]
    ds_read_b64_tr_b16 v[136:137], v6 offset:41984
    ds_read_b64_tr_b16 v[138:139], v6 offset:42496
    s_waitcnt lgkmcnt(4)
    v_mfma_f32_16x16x32_bf16 v[16:19], v[116:119], v[140:143], v[16:19]
    ds_read_b128 v[156:159], v2 offset:40960
    v_mfma_f32_16x16x32_bf16 v[20:23], v[116:119], v[144:147], v[20:23]
    ds_read_b128 v[160:163], v2 offset:43008
    v_mfma_f32_16x16x32_bf16 v[24:27], v[116:119], v[148:151], v[24:27]
    ds_read_b128 v[164:167], v173 offset:40960
    v_mfma_f32_16x16x32_bf16 v[28:31], v[116:119], v[152:155], v[28:31]
    ds_read_b64_tr_b16 v[116:117], v5 offset:53248
    v_mfma_f32_16x16x32_bf16 v[44:47], v[120:123], v[152:155], v[44:47]
    ds_read_b64_tr_b16 v[118:119], v5 offset:53760
    v_mfma_f32_16x16x32_bf16 v[40:43], v[120:123], v[148:151], v[40:43]
    ds_read_b128 v[168:171], v173 offset:43008
    v_mfma_f32_16x16x32_bf16 v[36:39], v[120:123], v[144:147], v[36:39]
    v_mfma_f32_16x16x32_bf16 v[32:35], v[120:123], v[140:143], v[32:35]
    ds_read_b64_tr_b16 v[120:121], v6 offset:53248
    v_mfma_f32_16x16x32_bf16 v[48:51], v[124:127], v[140:143], v[48:51]
    ds_read_b64_tr_b16 v[122:123], v6 offset:53760
    v_mfma_f32_16x16x32_bf16 v[52:55], v[124:127], v[144:147], v[52:55]
    v_mfma_f32_16x16x32_bf16 v[56:59], v[124:127], v[148:151], v[56:59]
    s_waitcnt lgkmcnt(4)
    v_mfma_f32_16x16x32_bf16 v[60:63], v[124:127], v[152:155], v[60:63]
    ds_read_b64_tr_b16 v[124:125], v7 offset:53248
    v_mfma_f32_16x16x32_bf16 v[76:79], v[128:131], v[152:155], v[76:79]
    ds_read_b64_tr_b16 v[126:127], v7 offset:53760
    v_mfma_f32_16x16x32_bf16 v[72:75], v[128:131], v[148:151], v[72:75]
    v_mfma_f32_16x16x32_bf16 v[68:71], v[128:131], v[144:147], v[68:71]
    v_mfma_f32_16x16x32_bf16 v[64:67], v[128:131], v[140:143], v[64:67]
    ds_read_b64_tr_b16 v[128:129], v8 offset:53248
    v_mfma_f32_16x16x32_bf16 v[80:83], v[132:135], v[140:143], v[80:83]
    ds_read_b64_tr_b16 v[130:131], v8 offset:53760
    v_mfma_f32_16x16x32_bf16 v[84:87], v[132:135], v[144:147], v[84:87]
    v_mfma_f32_16x16x32_bf16 v[88:91], v[132:135], v[148:151], v[88:91]
    v_mfma_f32_16x16x32_bf16 v[92:95], v[132:135], v[152:155], v[92:95]
    ds_read_b64_tr_b16 v[132:133], v5 offset:54272
    v_mfma_f32_16x16x32_bf16 v[108:111], v[136:139], v[152:155], v[108:111]
    ds_read_b64_tr_b16 v[134:135], v5 offset:54784
    v_mfma_f32_16x16x32_bf16 v[104:107], v[136:139], v[148:151], v[104:107]
    s_bitcmp1_b32 s70, 1
    v_mfma_f32_16x16x32_bf16 v[100:103], v[136:139], v[144:147], v[100:103]
    v_mfma_f32_16x16x32_bf16 v[96:99], v[136:139], v[140:143], v[96:99]
    ds_read_b64_tr_b16 v[136:137], v6 offset:54272
    ds_read_b64_tr_b16 v[138:139], v6 offset:54784
    s_cbranch_scc1 L_ev1
L_evback1:
    s_waitcnt lgkmcnt(4)
    v_mfma_f32_16x16x32_bf16 v[16:19], v[116:119], v[156:159], v[16:19]
    v_mfma_f32_16x16x32_bf16 v[20:23], v[116:119], v[160:163], v[20:23]
    v_mfma_f32_16x16x32_bf16 v[24:27], v[116:119], v[164:167], v[24:27]
    v_mfma_f32_16x16x32_bf16 v[28:31], v[116:119], v[168:171], v[28:31]
    v_mfma_f32_16x16x32_bf16 v[44:47], v[120:123], v[168:171], v[44:47]
    v_mfma_f32_16x16x32_bf16 v[40:43], v[120:123], v[164:167], v[40:43]
    s_waitcnt lgkmcnt(0)
    s_barrier
    v_mfma_f32_16x16x32_bf16 v[36:39], v[120:123], v[160:163], v[36:39]
    ds_read_b128 v[140:143], v3 offset:0
    v_mfma_f32_16x16x32_bf16 v[32:35], v[120:123], v[156:159], v[32:35]
    ds_read_b128 v[144:147], v3 offset:2048
    v_mfma_f32_16x16x32_bf16 v[48:51], v[124:127], v[156:159], v[48:51]
    ds_read_b128 v[148:151], v174 offset:0
    ds_read_b128 v[152:155], v174 offset:2048
    v_mfma_f32_16x16x32_bf16 v[52:55], v[124:127], v[160:163], v[52:55]
    ds_read_b64_tr_b16 v[116:117], v9 offset:0
    ds_read_b64_tr_b16 v[118:119], v9 offset:512
    v_mfma_f32_16x16x32_bf16 v[56:59], v[124:127], v[164:167], v[56:59]
    ds_read_b64_tr_b16 v[120:121], v10 offset:0
    ds_read_b64_tr_b16 v[122:123], v10 offset:512
    v_mfma_f32_16x16x32_bf16 v[60:63], v[124:127], v[168:171], v[60:63]
    ds_read_b64_tr_b16 v[124:125], v11 offset:0
    v_mfma_f32_16x16x32_bf16 v[76:79], v[128:131], v[168:171], v[76:79]
    ds_read_b64_tr_b16 v[126:127], v11 offset:512
    v_mfma_f32_16x16x32_bf16 v[72:75], v[128:131], v[164:167], v[72:75]
    v_mfma_f32_16x16x32_bf16 v[68:71], v[128:131], v[160:163], v[68:71]
    v_mfma_f32_16x16x32_bf16 v[64:67], v[128:131], v[156:159], v[64:67]
    ds_read_b64_tr_b16 v[128:129], v12 offset:0
    v_mfma_f32_16x16x32_bf16 v[80:83], v[132:135], v[156:159], v[80:83]
    ds_read_b64_tr_b16 v[130:131], v12 offset:512
    v_mfma_f32_16x16x32_bf16 v[84:87], v[132:135], v[160:163], v[84:87]
    v_mfma_f32_16x16x32_bf16 v[88:91], v[132:135], v[164:167], v[88:91]
    v_mfma_f32_16x16x32_bf16 v[92:95], v[132:135], v[168:171], v[92:95]
    ds_read_b64_tr_b16 v[132:133], v9 offset:1024
    v_mfma_f32_16x16x32_bf16 v[108:111], v[136:139], v[168:171], v[108:111]
    ds_read_b64_tr_b16 v[134:135], v9 offset:1536
    v_mfma_f32_16x16x32_bf16 v[104:107], v[136:139], v[164:167], v[104:107]
    v_mfma_f32_16x16x32_bf16 v[100:103], v[136:139], v[160:163], v[100:103]
    v_mfma_f32_16x16x32_bf16 v[96:99], v[136:139], v[156:159], v[96:99]
    ds_read_b64_tr_b16 v[136:137], v10 offset:1024
    ds_read_b64_tr_b16 v[138:139], v10 offset:1536
    s_waitcnt lgkmcnt(4)
    v_mfma_f32_16x16x32_bf16 v[16:19], v[116:119], v[140:143], v[16:19]
    ds_read_b128 v[156:159], v4 offset:0
    v_mfma_f32_16x16x32_bf16 v[20:23], v[116:119], v[144:147], v[20:23]
    ds_read_b128 v[160:163], v4 offset:2048
    v_mfma_f32_16x16x32_bf16 v[24:27], v[116:119], v[148:151], v[24:27]
    ds_read_b128 v[164:167], v175 offset:0
    v_mfma_f32_16x16x32_bf16 v[28:31], v[116:119], v[152:155], v[28:31]
    ds_read_b64_tr_b16 v[116:117], v9 offset:12288
    v_mfma_f32_16x16x32_bf16 v[44:47], v[120:123], v[152:155], v[44:47]
    ds_read_b64_tr_b16 v[118:119], v9 offset:12800
    v_mfma_f32_16x16x32_bf16 v[40:43], v[120:123], v[148:151], v[40:43]
    ds_read_b128 v[168:171], v175 offset:2048
    v_mfma_f32_16x16x32_bf16 v[36:39], v[120:123], v[144:147], v[36:39]
    v_mfma_f32_16x16x32_bf16 v[32:35], v[120:123], v[140:143], v[32:35]
    ds_read_b64_tr_b16 v[120:121], v10 offset:12288
    v_mfma_f32_16x16x32_bf16 v[48:51], v[124:127], v[140:143], v[48:51]
    ds_read_b64_tr_b16 v[122:123], v10 offset:12800
    v_mfma_f32_16x16x32_bf16 v[52:55], v[124:127], v[144:147], v[52:55]
    v_mfma_f32_16x16x32_bf16 v[56:59], v[124:127], v[148:151], v[56:59]
    s_waitcnt lgkmcnt(4)
    v_mfma_f32_16x16x32_bf16 v[60:63], v[124:127], v[152:155], v[60:63]
    ds_read_b64_tr_b16 v[124:125], v11 offset:12288
    v_mfma_f32_16x16x32_bf16 v[76:79], v[128:131], v[152:155], v[76:79]
    ds_read_b64_tr_b16 v[126:127], v11 offset:12800
    v_mfma_f32_16x16x32_bf16 v[72:75], v[128:131], v[148:151], v[72:75]
    v_mfma_f32_16x16x32_bf16 v[68:71], v[128:131], v[144:147], v[68:71]
    v_mfma_f32_16x16x32_bf16 v[64:67], v[128:131], v[140:143], v[64:67]
    ds_read_b64_tr_b16 v[128:129], v12 offset:12288
    v_mfma_f32_16x16x32_bf16 v[80:83], v[132:135], v[140:143], v[80:83]
    ds_read_b64_tr_b16 v[130:131], v12 offset:12800
    v_mfma_f32_16x16x32_bf16 v[84:87], v[132:135], v[144:147], v[84:87]
    v_mfma_f32_16x16x32_bf16 v[88:91], v[132:135], v[148:151], v[88:91]
    v_mfma_f32_16x16x32_bf16 v[92:95], v[132:135], v[152:155], v[92:95]
    ds_read_b64_tr_b16 v[132:133], v9 offset:13312
    v_mfma_f32_16x16x32_bf16 v[108:111], v[136:139], v[152:155], v[108:111]
    ds_read_b64_tr_b16 v[134:135], v9 offset:13824
    v_mfma_f32_16x16x32_bf16 v[104:107], v[136:139], v[148:151], v[104:107]
    s_bitcmp1_b32 s70, 2
    v_mfma_f32_16x16x32_bf16 v[100:103], v[136:139], v[144:147], v[100:103]
    v_mfma_f32_16x16x32_bf16 v[96:99], v[136:139], v[140:143], v[96:99]
    ds_read_b64_tr_b16 v[136:137], v10 offset:13312
    ds_read_b64_tr_b16 v[138:139], v10 offset:13824
    s_cbranch_scc1 L_ev2
L_evback2:
    s_waitcnt lgkmcnt(4)
    v_mfma_f32_16x16x32_bf16 v[16:19], v[116:119], v[156:159], v[16:19]
    s_lshr_b32 s70, s70, 3
    s_lshr_b32 s74, s74, 3
    v_mfma_f32_16x16x32_bf16 v[20:23], v[116:119], v[160:163], v[20:23]
    s_lshr_b32 s75, s75, 3
    s_add_u32 s71, s71, 1
    v_mfma_f32_16x16x32_bf16 v[24:27], v[116:119], v[164:167], v[24:27]
    v_mfma_f32_16x16x32_bf16 v[28:31], v[116:119], v[168:171], v[28:31]
    v_mfma_f32_16x16x32_bf16 v[44:47], v[120:123], v[168:171], v[44:47]
    v_mfma_f32_16x16x32_bf16 v[40:43], v[120:123], v[164:167], v[40:43]
    s_waitcnt lgkmcnt(0)
    s_barrier
    v_mfma_f32_16x16x32_bf16 v[36:39], v[120:123], v[160:163], v[36:39]
    ds_read_b128 v[140:143], v1 offset:0
    v_mfma_f32_16x16x32_bf16 v[32:35], v[120:123], v[156:159], v[32:35]
    ds_read_b128 v[144:147], v1 offset:2048
    v_mfma_f32_16x16x32_bf16 v[48:51], v[124:127], v[156:159], v[48:51]
    ds_read_b128 v[148:151], v172 offset:0
    ds_read_b128 v[152:155], v172 offset:2048
    v_mfma_f32_16x16x32_bf16 v[52:55], v[124:127], v[160:163], v[52:55]
    ds_read_b64_tr_b16 v[116:117], v5 offset:0
    ds_read_b64_tr_b16 v[118:119], v5 offset:512
    v_mfma_f32_16x16x32_bf16 v[56:59], v[124:127], v[164:167], v[56:59]
    ds_read_b64_tr_b16 v[120:121], v6 offset:0
    ds_read_b64_tr_b16 v[122:123], v6 offset:512
    v_mfma_f32_16x16x32_bf16 v[60:63], v[124:127], v[168:171], v[60:63]
    ds_read_b64_tr_b16 v[124:125], v7 offset:0
    v_mfma_f32_16x16x32_bf16 v[76:79], v[128:131], v[168:171], v[76:79]
    ds_read_b64_tr_b16 v[126:127], v7 offset:512
    v_mfma_f32_16x16x32_bf16 v[72:75], v[128:131], v[164:167], v[72:75]
    v_mfma_f32_16x16x32_bf16 v[68:71], v[128:131], v[160:163], v[68:71]
    v_mfma_f32_16x16x32_bf16 v[64:67], v[128:131], v[156:159], v[64:67]
    ds_read_b64_tr_b16 v[128:129], v8 offset:0
    v_mfma_f32_16x16x32_bf16 v[80:83], v[132:135], v[156:159], v[80:83]
    ds_read_b64_tr_b16 v[130:131], v8 offset:512
    v_mfma_f32_16x16x32_bf16 v[84:87], v[132:135], v[160:163], v[84:87]
    v_mfma_f32_16x16x32_bf16 v[88:91], v[132:135], v[164:167], v[88:91]
    v_mfma_f32_16x16x32_bf16 v[92:95], v[132:135], v[168:171], v[92:95]
    ds_read_b64_tr_b16 v[132:133], v5 offset:1024
    v_mfma_f32_16x16x32_bf16 v[108:111], v[136:139], v[168:171], v[108:111]
    ds_read_b64_tr_b16 v[134:135], v5 offset:1536
    v_mfma_f32_16x16x32_bf16 v[104:107], v[136:139], v[164:167], v[104:107]
    s_cmp_lt_u32 s71, 3
    v_mfma_f32_16x16x32_bf16 v[100:103], v[136:139], v[160:163], v[100:103]
    v_mfma_f32_16x16x32_bf16 v[96:99], v[136:139], v[156:159], v[96:99]
    ds_read_b64_tr_b16 v[136:137], v6 offset:1024
    ds_read_b64_tr_b16 v[138:139], v6 offset:1536
    s_cbranch_scc1 L_p1
    s_waitcnt lgkmcnt(4)
    v_mfma_f32_16x16x32_bf16 v[16:19], v[116:119], v[140:143], v[16:19]
    ds_read_b128 v[156:159], v2 offset:0
    v_mfma_f32_16x16x32_bf16 v[20:23], v[116:119], v[144:147], v[20:23]
    ds_read_b128 v[160:163], v2 offset:2048
    v_mfma_f32_16x16x32_bf16 v[24:27], v[116:119], v[148:151], v[24:27]
    ds_read_b128 v[164:167], v173 offset:0
    v_mfma_f32_16x16x32_bf16 v[28:31], v[116:119], v[152:155], v[28:31]
    ds_read_b64_tr_b16 v[116:117], v5 offset:12288
    v_mfma_f32_16x16x32_bf16 v[44:47], v[120:123], v[152:155], v[44:47]
    ds_read_b64_tr_b16 v[118:119], v5 offset:12800
    v_mfma_f32_16x16x32_bf16 v[40:43], v[120:123], v[148:151], v[40:43]
    ds_read_b128 v[168:171], v173 offset:2048
    v_mfma_f32_16x16x32_bf16 v[36:39], v[120:123], v[144:147], v[36:39]
    v_mfma_f32_16x16x32_bf16 v[32:35], v[120:123], v[140:143], v[32:35]
    ds_read_b64_tr_b16 v[120:121], v6 offset:12288
    v_mfma_f32_16x16x32_bf16 v[48:51], v[124:127], v[140:143], v[48:51]
    ds_read_b64_tr_b16 v[122:123], v6 offset:12800
    v_mfma_f32_16x16x32_bf16 v[52:55], v[124:127], v[144:147], v[52:55]
    v_mfma_f32_16x16x32_bf16 v[56:59], v[124:127], v[148:151], v[56:59]
    s_waitcnt lgkmcnt(4)
    v_mfma_f32_16x16x32_bf16 v[60:63], v[124:127], v[152:155], v[60:63]
    ds_read_b64_tr_b16 v[124:125], v7 offset:12288
    v_mfma_f32_16x16x32_bf16 v[76:79], v[128:131], v[152:155], v[76:79]
    ds_read_b64_tr_b16 v[126:127], v7 offset:12800
    v_mfma_f32_16x16x32_bf16 v[72:75], v[128:131], v[148:151], v[72:75]
    v_mfma_f32_16x16x32_bf16 v[68:71], v[128:131], v[144:147], v[68:71]
    v_mfma_f32_16x16x32_bf16 v[64:67], v[128:131], v[140:143], v[64:67]
    ds_read_b64_tr_b16 v[128:129], v8 offset:12288
    v_mfma_f32_16x16x32_bf16 v[80:83], v[132:135], v[140:143], v[80:83]
    ds_read_b64_tr_b16 v[130:131], v8 offset:12800
    v_mfma_f32_16x16x32_bf16 v[84:87], v[132:135], v[144:147], v[84:87]
    v_mfma_f32_16x16x32_bf16 v[88:91], v[132:135], v[148:151], v[88:91]
    v_mfma_f32_16x16x32_bf16 v[92:95], v[132:135], v[152:155], v[92:95]
    ds_read_b64_tr_b16 v[132:133], v5 offset:13312
    v_mfma_f32_16x16x32_bf16 v[108:111], v[136:139], v[152:155], v[108:111]
    ds_read_b64_tr_b16 v[134:135], v5 offset:13824
    v_mfma_f32_16x16x32_bf16 v[104:107], v[136:139], v[148:151], v[104:107]
    s_bitcmp1_b32 s70, 0
    v_mfma_f32_16x16x32_bf16 v[100:103], v[136:139], v[144:147], v[100:103]
    v_mfma_f32_16x16x32_bf16 v[96:99], v[136:139], v[140:143], v[96:99]
    ds_read_b64_tr_b16 v[136:137], v6 offset:13312
    ds_read_b64_tr_b16 v[138:139], v6 offset:13824
    s_cbranch_scc1 L_ev3
L_evback3:
    s_waitcnt lgkmcnt(4)
    v_mfma_f32_16x16x32_bf16 v[16:19], v[116:119], v[156:159], v[16:19]
    s_waitcnt vmcnt(0)
    v_mfma_f32_16x16x32_bf16 v[20:23], v[116:119], v[160:163], v[20:23]
    v_add_u32 v1, s64, v13
    v_mfma_f32_16x16x32_bf16 v[24:27], v[116:119], v[164:167], v[24:27]
    v_xor_b32 v2, 4096, v1
    v_mfma_f32_16x16x32_bf16 v[28:31], v[116:119], v[168:171], v[28:31]
    v_mfma_f32_16x16x32_bf16 v[44:47], v[120:123], v[168:171], v[44:47]
    v_mfma_f32_16x16x32_bf16 v[40:43], v[120:123], v[164:167], v[40:43]
    s_waitcnt lgkmcnt(0)
    v_mfma_f32_16x16x32_bf16 v[36:39], v[120:123], v[160:163], v[36:39]
    v_mfma_f32_16x16x32_bf16 v[32:35], v[120:123], v[156:159], v[32:35]
    v_mfma_f32_16x16x32_bf16 v[48:51], v[124:127], v[156:159], v[48:51]
    v_mfma_f32_16x16x32_bf16 v[52:55], v[124:127], v[160:163], v[52:55]
    v_mfma_f32_16x16x32_bf16 v[56:59], v[124:127], v[164:167], v[56:59]
    v_cvt_pk_bf16_f32 v24, v24, v25
    v_cvt_pk_bf16_f32 v25, v26, v27
    v_mfma_f32_16x16x32_bf16 v[60:63], v[124:127], v[168:171], v[60:63]
    v_cvt_pk_bf16_f32 v26, v40, v41
    v_cvt_pk_bf16_f32 v27, v42, v43
    v_mfma_f32_16x16x32_bf16 v[76:79], v[128:131], v[168:171], v[76:79]
    v_cvt_pk_bf16_f32 v28, v28, v29
    v_cvt_pk_bf16_f32 v29, v30, v31
    v_mfma_f32_16x16x32_bf16 v[72:75], v[128:131], v[164:167], v[72:75]
    v_cvt_pk_bf16_f32 v30, v44, v45
    v_cvt_pk_bf16_f32 v31, v46, v47
    v_mfma_f32_16x16x32_bf16 v[68:71], v[128:131], v[160:163], v[68:71]
    v_cvt_pk_bf16_f32 v16, v16, v17
    v_cvt_pk_bf16_f32 v17, v18, v19
    v_mfma_f32_16x16x32_bf16 v[64:67], v[128:131], v[156:159], v[64:67]
    v_cvt_pk_bf16_f32 v18, v32, v33
    v_cvt_pk_bf16_f32 v19, v34, v35
    v_mfma_f32_16x16x32_bf16 v[80:83], v[132:135], v[156:159], v[80:83]
    v_cvt_pk_bf16_f32 v20, v20, v21
    v_cvt_pk_bf16_f32 v21, v22, v23
    v_mfma_f32_16x16x32_bf16 v[84:87], v[132:135], v[160:163], v[84:87]
    v_cvt_pk_bf16_f32 v22, v36, v37
    v_cvt_pk_bf16_f32 v23, v38, v39
    v_mfma_f32_16x16x32_bf16 v[88:91], v[132:135], v[164:167], v[88:91]
    v_cvt_pk_bf16_f32 v56, v56, v57
    v_cvt_pk_bf16_f32 v57, v58, v59
    v_mfma_f32_16x16x32_bf16 v[92:95], v[132:135], v[168:171], v[92:95]
    v_cvt_pk_bf16_f32 v58, v72, v73
    v_cvt_pk_bf16_f32 v59, v74, v75
    v_mfma_f32_16x16x32_bf16 v[108:111], v[136:139], v[168:171], v[108:111]
    v_cvt_pk_bf16_f32 v60, v60, v61
    v_cvt_pk_bf16_f32 v61, v62, v63
    v_mfma_f32_16x16x32_bf16 v[104:107], v[136:139], v[164:167], v[104:107]
    v_cvt_pk_bf16_f32 v62, v76, v77
    v_cvt_pk_bf16_f32 v63, v78, v79
    v_mfma_f32_16x16x32_bf16 v[100:103], v[136:139], v[160:163], v[100:103]
    v_cvt_pk_bf16_f32 v48, v48, v49
    v_cvt_pk_bf16_f32 v49, v50, v51
    v_mfma_f32_16x16x32_bf16 v[96:99], v[136:139], v[156:159], v[96:99]
    v_cvt_pk_bf16_f32 v50, v64, v65
    v_cvt_pk_bf16_f32 v51, v66, v67
    v_mfma_f32_16x16x32_bf16 v[116:119], v[192:195], v[24:27], 0
    v_cvt_pk_bf16_f32 v52, v52, v53
    v_cvt_pk_bf16_f32 v53, v54, v55
    v_mfma_f32_16x16x32_bf16 v[120:123], v[192:195], v[28:31], 0
    v_cvt_pk_bf16_f32 v54, v68, v69
    v_cvt_pk_bf16_f32 v55, v70, v71
    v_mfma_f32_16x16x32_bf16 v[124:127], v[216:219], v[24:27], 0
    v_cvt_pk_bf16_f32 v88, v88, v89
    v_cvt_pk_bf16_f32 v89, v90, v91
    v_mfma_f32_16x16x32_bf16 v[128:131], v[216:219], v[28:31], 0
    v_cvt_pk_bf16_f32 v90, v104, v105
    v_cvt_pk_bf16_f32 v91, v106, v107
    v_mfma_f32_16x16x32_bf16 v[116:119], v[196:199], v[56:59], v[116:119]
    v_cvt_pk_bf16_f32 v92, v92, v93
    v_cvt_pk_bf16_f32 v93, v94, v95
    v_mfma_f32_16x16x32_bf16 v[120:123], v[196:199], v[60:63], v[120:123]
    v_cvt_pk_bf16_f32 v94, v108, v109
    v_cvt_pk_bf16_f32 v95, v110, v111
    v_mfma_f32_16x16x32_bf16 v[124:127], v[220:223], v[56:59], v[124:127]
    v_cvt_pk_bf16_f32 v80, v80, v81
    v_cvt_pk_bf16_f32 v81, v82, v83
    v_mfma_f32_16x16x32_bf16 v[128:131], v[220:223], v[60:63], v[128:131]
    v_cvt_pk_bf16_f32 v82, v96, v97
    v_cvt_pk_bf16_f32 v83, v98, v99
    v_mfma_f32_16x16x32_bf16 v[116:119], v[200:203], v[88:91], v[116:119]
    v_cvt_pk_bf16_f32 v84, v84, v85
    v_cvt_pk_bf16_f32 v85, v86, v87
    v_mfma_f32_16x16x32_bf16 v[120:123], v[200:203], v[92:95], v[120:123]
    v_cvt_pk_bf16_f32 v86, v100, v101
    v_cvt_pk_bf16_f32 v87, v102, v103
    v_mfma_f32_16x16x32_bf16 v[124:127], v[224:227], v[88:91], v[124:127]
    v_mfma_f32_16x16x32_bf16 v[128:131], v[224:227], v[92:95], v[128:131]
    v_mfma_f32_16x16x32_bf16 v[228:231], v[180:183], v[16:19], 0
    v_mfma_f32_16x16x32_bf16 v[232:235], v[180:183], v[20:23], 0
    ds_write_b128 v1, v[116:119] offset:0
    v_mfma_f32_16x16x32_bf16 v[236:239], v[204:207], v[16:19], 0
    ds_write_b128 v1, v[120:123] offset:1024
    v_mfma_f32_16x16x32_bf16 v[240:243], v[204:207], v[20:23], 0
    s_nop 0
    ds_write_b128 v1, v[124:127] offset:2048
    v_mfma_f32_16x16x32_bf16 v[228:231], v[184:187], v[48:51], v[228:231]
    ds_write_b128 v1, v[128:131] offset:3072
    v_mfma_f32_16x16x32_bf16 v[232:235], v[184:187], v[52:55], v[232:235]
    s_waitcnt lgkmcnt(0)
    s_barrier
    v_mfma_f32_16x16x32_bf16 v[236:239], v[208:211], v[48:51], v[236:239]
    ds_read_b128 v[116:119], v2 offset:0
    ds_read_b128 v[120:123], v2 offset:1024
    v_mfma_f32_16x16x32_bf16 v[240:243], v[208:211], v[52:55], v[240:243]
    ds_read_b128 v[124:127], v2 offset:2048
    ds_read_b128 v[128:131], v2 offset:3072
    v_mfma_f32_16x16x32_bf16 v[228:231], v[188:191], v[80:83], v[228:231]
    v_mfma_f32_16x16x32_bf16 v[232:235], v[188:191], v[84:87], v[232:235]
    v_mfma_f32_16x16x32_bf16 v[236:239], v[212:215], v[80:83], v[236:239]
    v_mfma_f32_16x16x32_bf16 v[240:243], v[212:215], v[84:87], v[240:243]
    s_waitcnt lgkmcnt(3)
    s_nop 3
    v_add_f32 v228, v228, v116
    v_add_f32 v229, v229, v117
    v_add_f32 v230, v230, v118
    v_add_f32 v231, v231, v119
    s_waitcnt lgkmcnt(2)
    v_add_f32 v232, v232, v120
    v_add_f32 v233, v233, v121
    v_add_f32 v234, v234, v122
    v_add_f32 v235, v235, v123
    s_waitcnt lgkmcnt(1)
    v_add_f32 v236, v236, v124
    v_add_f32 v237, v237, v125
    v_add_f32 v238, v238, v126
    v_add_f32 v239, v239, v127
    s_waitcnt lgkmcnt(0)
    v_add_f32 v240, v240, v128
    v_add_f32 v241, v241, v129
    v_add_f32 v242, v242, v130
    v_add_f32 v243, v243, v131
    v_max3_f32 v252, v228, v229, v230
    v_max3_f32 v253, v232, v233, v234
    v_max3_f32 v252, v252, v231, v236
    ds_read_b128 v[164:167], v244 offset:40960
    v_max3_f32 v253, v253, v235, v240
    v_max3_f32 v252, v252, v237, v238
    v_max3_f32 v253, v253, v241, v242
    v_max_f32 v252, v252, v239
    ds_read_b128 v[168:171], v244 offset:43008
    v_max_f32 v253, v253, v243
    v_mov_b32 v180, v252
    v_mov_b32 v181, v253
    s_nop 0
    v_permlane16_swap_b32 v252, v180
    v_permlane16_swap_b32 v253, v181
    s_nop 0
    v_max_f32 v252, v252, v180
    ds_read_b128 v[172:175], v244 offset:45056
    v_max_f32 v253, v253, v181
    v_mov_b32 v180, v252
    v_mov_b32 v181, v253
    s_nop 0
    v_permlane32_swap_b32 v252, v180
    v_permlane32_swap_b32 v253, v181
    s_nop 0
    v_max_f32 v252, v252, v180
    ds_read_b128 v[176:179], v244 offset:47104
    v_max_f32 v253, v253, v181
    v_mul_f32 v252, s72, v252
    v_mul_f32 v253, s72, v253
    v_fma_f32 v228, v228, s72, -v252
    ds_read_b64_tr_b16 v[96:97], v248 offset:40960
    v_fma_f32 v229, v229, s72, -v252
    v_fma_f32 v230, v230, s72, -v252
    v_fma_f32 v231, v231, s72, -v252
    v_fma_f32 v236, v236, s72, -v252
    ds_read_b64_tr_b16 v[98:99], v248 offset:42240
    v_fma_f32 v237, v237, s72, -v252
    v_fma_f32 v238, v238, s72, -v252
    v_fma_f32 v239, v239, s72, -v252
    v_fma_f32 v232, v232, s72, -v253
    ds_read_b64_tr_b16 v[100:101], v249 offset:40992
    v_fma_f32 v233, v233, s72, -v253
    v_fma_f32 v234, v234, s72, -v253
    v_fma_f32 v235, v235, s72, -v253
    v_fma_f32 v240, v240, s72, -v253
    ds_read_b64_tr_b16 v[102:103], v249 offset:42272
    v_fma_f32 v241, v241, s72, -v253
    v_fma_f32 v242, v242, s72, -v253
    v_fma_f32 v243, v243, s72, -v253
    v_exp_f32 v228, v228
    ds_read_b64_tr_b16 v[104:105], v248 offset:41024
    v_exp_f32 v229, v229
    v_exp_f32 v230, v230
    v_exp_f32 v231, v231
    v_exp_f32 v236, v236
    ds_read_b64_tr_b16 v[106:107], v248 offset:42304
    v_exp_f32 v237, v237
    v_exp_f32 v238, v238
    v_exp_f32 v239, v239
    v_exp_f32 v232, v232
    ds_read_b64_tr_b16 v[108:109], v249 offset:41056
    v_exp_f32 v233, v233
    v_exp_f32 v234, v234
    v_exp_f32 v235, v235
    v_exp_f32 v240, v240
    ds_read_b64_tr_b16 v[110:111], v249 offset:42336
    v_exp_f32 v241, v241
    v_exp_f32 v242, v242
    v_exp_f32 v243, v243
    v_add_f32 v252, v228, v229
    ds_read_b64_tr_b16 v[112:113], v248 offset:41088
    v_add_f32 v253, v232, v233
    v_add_f32 v252, v252, v230
    v_add_f32 v253, v253, v234
    v_add_f32 v252, v252, v231
    ds_read_b64_tr_b16 v[114:115], v248 offset:42368
    v_add_f32 v253, v253, v235
    v_add_f32 v252, v252, v236
    v_add_f32 v253, v253, v240
    v_add_f32 v252, v252, v237
    v_add_f32 v253, v253, v241
    v_add_f32 v252, v252, v238
    v_add_f32 v253, v253, v242
    v_add_f32 v252, v252, v239
    v_add_f32 v253, v253, v243
    v_mov_b32 v180, v252
    v_mov_b32 v181, v253
    s_nop 0
    v_permlane16_swap_b32 v252, v180
    v_permlane16_swap_b32 v253, v181
    s_nop 0
    v_add_f32 v252, v252, v180
    v_add_f32 v253, v253, v181
    v_mov_b32 v180, v252
    v_mov_b32 v181, v253
    s_nop 0
    v_permlane32_swap_b32 v252, v180
    v_permlane32_swap_b32 v253, v181
    s_nop 0
    v_add_f32 v252, v252, v180
    v_add_f32 v253, v253, v181
    v_rcp_f32 v252, v252
    v_rcp_f32 v253, v253
    s_nop 0
    v_mul_f32 v228, v228, v252
    v_mul_f32 v229, v229, v252
    v_mul_f32 v230, v230, v252
    v_mul_f32 v231, v231, v252
    v_mul_f32 v236, v236, v252
    v_mul_f32 v237, v237, v252
    v_mul_f32 v238, v238, v252
    v_mul_f32 v239, v239, v252
    v_mul_f32 v232, v232, v253
    v_mul_f32 v233, v233, v253
    v_mul_f32 v234, v234, v253
    v_mul_f32 v235, v235, v253
    v_mul_f32 v240, v240, v253
    v_mul_f32 v241, v241, v253
    v_mul_f32 v242, v242, v253
    v_mul_f32 v243, v243, v253
    v_cvt_pk_bf16_f32 v132, v228, v229
    v_cvt_pk_bf16_f32 v133, v230, v231
    v_cvt_pk_bf16_f32 v134, v236, v237
    v_cvt_pk_bf16_f32 v135, v238, v239
    v_cvt_pk_bf16_f32 v136, v232, v233
    v_cvt_pk_bf16_f32 v137, v234, v235
    v_cvt_pk_bf16_f32 v138, v240, v241
    v_cvt_pk_bf16_f32 v139, v242, v243
    buffer_store_dwordx4 v[132:135], v13, s[28:31], s69 offen sc1
    buffer_store_dwordx4 v[136:139], v13, s[28:31], s69 offen offset:1024 sc1
    s_bfe_u32 s65, s38, 0x10003
    s_xor_b32 s65, s65, 1
    s_xor_b32 s4, s65, s41
    s_lshl_b32 s4, s4, 11
    s_add_u32 s4, s4, 122880
    v_add_u32 v180, s4, v13
    ds_write_b128 v180, v[132:135]
    ds_write_b128 v180, v[136:139] offset:1024
    s_waitcnt lgkmcnt(10)
    v_mfma_f32_16x16x32_bf16 v[148:151], v[164:167], v[96:99], 0
    ds_read_b128 v[116:119], v245 offset:40960
    v_mfma_f32_16x16x32_bf16 v[152:155], v[168:171], v[96:99], 0
    ds_read_b128 v[120:123], v245 offset:43008
    v_mfma_f32_16x16x32_bf16 v[156:159], v[172:175], v[96:99], 0
    ds_read_b128 v[124:127], v245 offset:45056
    v_mfma_f32_16x16x32_bf16 v[160:163], v[176:179], v[96:99], 0
    ds_read_b64_tr_b16 v[96:97], v248 offset:51200
    s_waitcnt lgkmcnt(12)
    v_mfma_f32_16x16x32_bf16 v[192:195], v[176:179], v[100:103], 0
    ds_read_b64_tr_b16 v[98:99], v248 offset:52480
    v_mfma_f32_16x16x32_bf16 v[188:191], v[172:175], v[100:103], 0
    ds_read_b128 v[128:131], v245 offset:47104
    v_mfma_f32_16x16x32_bf16 v[184:187], v[168:171], v[100:103], 0
    v_lshrrev_b32 v4, 3, v0
    s_waitcnt lgkmcnt(6)
    v_mfma_f32_16x16x32_bf16 v[180:183], v[164:167], v[100:103], 0
    ds_read_b64_tr_b16 v[100:101], v249 offset:51232
    v_mfma_f32_16x16x32_bf16 v[196:199], v[164:167], v[104:107], 0
    ds_read_b64_tr_b16 v[102:103], v249 offset:52512
    v_mfma_f32_16x16x32_bf16 v[200:203], v[168:171], v[104:107], 0
    v_min_u32 v4, 1, v4
    v_mfma_f32_16x16x32_bf16 v[204:207], v[172:175], v[104:107], 0
    v_lshl_or_b32 v4, v4, 31, v13
    v_mfma_f32_16x16x32_bf16 v[208:211], v[176:179], v[104:107], 0
    ds_read_b64_tr_b16 v[104:105], v248 offset:51264
    v_mfma_f32_16x16x32_bf16 v[224:227], v[176:179], v[108:111], 0
    ds_read_b64_tr_b16 v[106:107], v248 offset:52544
    v_mfma_f32_16x16x32_bf16 v[220:223], v[172:175], v[108:111], 0
    v_mov_b32 v8, 0
    v_mfma_f32_16x16x32_bf16 v[216:219], v[168:171], v[108:111], 0
    v_mov_b32 v9, 0
    v_mfma_f32_16x16x32_bf16 v[212:215], v[164:167], v[108:111], 0
    ds_read_b64_tr_b16 v[108:109], v249 offset:51296
    v_mfma_f32_16x16x32_bf16 v[228:231], v[164:167], v[112:115], 0
    ds_read_b64_tr_b16 v[110:111], v249 offset:52576
    v_mfma_f32_16x16x32_bf16 v[232:235], v[168:171], v[112:115], 0
    v_mov_b32 v10, 0
    v_mfma_f32_16x16x32_bf16 v[236:239], v[172:175], v[112:115], 0
    v_mov_b32 v11, 0
    v_mfma_f32_16x16x32_bf16 v[240:243], v[176:179], v[112:115], 0
    ds_read_b64_tr_b16 v[112:113], v248 offset:51328
    ds_read_b64_tr_b16 v[114:115], v248 offset:52608
    s_waitcnt lgkmcnt(4)
    v_mfma_f32_16x16x32_bf16 v[148:151], v[116:119], v[96:99], v[148:151]
    v_mfma_f32_16x16x32_bf16 v[152:155], v[120:123], v[96:99], v[152:155]
    v_mfma_f32_16x16x32_bf16 v[156:159], v[124:127], v[96:99], v[156:159]
    v_mfma_f32_16x16x32_bf16 v[160:163], v[128:131], v[96:99], v[160:163]
    v_mfma_f32_16x16x32_bf16 v[192:195], v[128:131], v[100:103], v[192:195]
    s_waitcnt lgkmcnt(0)
    s_barrier
    v_mfma_f32_16x16x32_bf16 v[188:191], v[124:127], v[100:103], v[188:191]
    ds_read_b128 v[164:167], v246 offset:0
    v_mfma_f32_16x16x32_bf16 v[184:187], v[120:123], v[100:103], v[184:187]
    ds_read_b128 v[168:171], v246 offset:2048
    v_mfma_f32_16x16x32_bf16 v[180:183], v[116:119], v[100:103], v[180:183]
    ds_read_b128 v[172:175], v246 offset:4096
    ds_read_b128 v[176:179], v246 offset:6144
    v_mfma_f32_16x16x32_bf16 v[196:199], v[116:119], v[104:107], v[196:199]
    ds_read_b64_tr_b16 v[96:97], v250 offset:0
    ds_read_b64_tr_b16 v[98:99], v250 offset:1280
    v_mfma_f32_16x16x32_bf16 v[200:203], v[120:123], v[104:107], v[200:203]
    ds_read_b64_tr_b16 v[100:101], v251 offset:32
    v_mfma_f32_16x16x32_bf16 v[204:207], v[124:127], v[104:107], v[204:207]
    ds_read_b64_tr_b16 v[102:103], v251 offset:1312
    v_mfma_f32_16x16x32_bf16 v[208:211], v[128:131], v[104:107], v[208:211]
    ds_read_b64_tr_b16 v[104:105], v250 offset:64
    v_mfma_f32_16x16x32_bf16 v[224:227], v[128:131], v[108:111], v[224:227]
    ds_read_b64_tr_b16 v[106:107], v250 offset:1344
    v_mfma_f32_16x16x32_bf16 v[220:223], v[124:127], v[108:111], v[220:223]
    v_mfma_f32_16x16x32_bf16 v[216:219], v[120:123], v[108:111], v[216:219]
    v_mfma_f32_16x16x32_bf16 v[212:215], v[116:119], v[108:111], v[212:215]
    ds_read_b64_tr_b16 v[108:109], v251 offset:96
    v_mfma_f32_16x16x32_bf16 v[228:231], v[116:119], v[112:115], v[228:231]
    ds_read_b64_tr_b16 v[110:111], v251 offset:1376
    v_mfma_f32_16x16x32_bf16 v[232:235], v[120:123], v[112:115], v[232:235]
    v_mfma_f32_16x16x32_bf16 v[236:239], v[124:127], v[112:115], v[236:239]
    v_mfma_f32_16x16x32_bf16 v[240:243], v[128:131], v[112:115], v[240:243]
    ds_read_b64_tr_b16 v[112:113], v250 offset:128
    ds_read_b64_tr_b16 v[114:115], v250 offset:1408
    s_waitcnt lgkmcnt(4)
    v_mfma_f32_16x16x32_bf16 v[148:151], v[164:167], v[96:99], v[148:151]
    ds_read_b128 v[116:119], v247 offset:0
    v_mfma_f32_16x16x32_bf16 v[152:155], v[168:171], v[96:99], v[152:155]
    ds_read_b128 v[120:123], v247 offset:2048
    v_mfma_f32_16x16x32_bf16 v[156:159], v[172:175], v[96:99], v[156:159]
    ds_read_b128 v[124:127], v247 offset:4096
    v_mfma_f32_16x16x32_bf16 v[160:163], v[176:179], v[96:99], v[160:163]
    ds_read_b64_tr_b16 v[96:97], v250 offset:10240
    v_mfma_f32_16x16x32_bf16 v[192:195], v[176:179], v[100:103], v[192:195]
    ds_read_b64_tr_b16 v[98:99], v250 offset:11520
    v_mfma_f32_16x16x32_bf16 v[188:191], v[172:175], v[100:103], v[188:191]
    ds_read_b128 v[128:131], v247 offset:6144
    v_mfma_f32_16x16x32_bf16 v[184:187], v[168:171], v[100:103], v[184:187]
    s_waitcnt lgkmcnt(6)
    v_mfma_f32_16x16x32_bf16 v[180:183], v[164:167], v[100:103], v[180:183]
    ds_read_b64_tr_b16 v[100:101], v251 offset:10272
    v_mfma_f32_16x16x32_bf16 v[196:199], v[164:167], v[104:107], v[196:199]
    ds_read_b64_tr_b16 v[102:103], v251 offset:11552
    v_mfma_f32_16x16x32_bf16 v[200:203], v[168:171], v[104:107], v[200:203]
    v_mfma_f32_16x16x32_bf16 v[204:207], v[172:175], v[104:107], v[204:207]
    v_mfma_f32_16x16x32_bf16 v[208:211], v[176:179], v[104:107], v[208:211]
    ds_read_b64_tr_b16 v[104:105], v250 offset:10304
    v_mfma_f32_16x16x32_bf16 v[224:227], v[176:179], v[108:111], v[224:227]
    ds_read_b64_tr_b16 v[106:107], v250 offset:11584
    v_mfma_f32_16x16x32_bf16 v[220:223], v[172:175], v[108:111], v[220:223]
    v_mfma_f32_16x16x32_bf16 v[216:219], v[168:171], v[108:111], v[216:219]
    v_mfma_f32_16x16x32_bf16 v[212:215], v[164:167], v[108:111], v[212:215]
    ds_read_b64_tr_b16 v[108:109], v251 offset:10336
    v_mfma_f32_16x16x32_bf16 v[228:231], v[164:167], v[112:115], v[228:231]
    ds_read_b64_tr_b16 v[110:111], v251 offset:11616
    v_mfma_f32_16x16x32_bf16 v[232:235], v[168:171], v[112:115], v[232:235]
    v_mfma_f32_16x16x32_bf16 v[236:239], v[172:175], v[112:115], v[236:239]
    v_mfma_f32_16x16x32_bf16 v[240:243], v[176:179], v[112:115], v[240:243]
    ds_read_b64_tr_b16 v[112:113], v250 offset:10368
    ds_read_b64_tr_b16 v[114:115], v250 offset:11648
    s_waitcnt lgkmcnt(4)
    v_mfma_f32_16x16x32_bf16 v[148:151], v[116:119], v[96:99], v[148:151]
    v_mfma_f32_16x16x32_bf16 v[152:155], v[120:123], v[96:99], v[152:155]
    v_mfma_f32_16x16x32_bf16 v[156:159], v[124:127], v[96:99], v[156:159]
    s_waitcnt vmcnt(0)
    buffer_store_dwordx4 v[8:11], v4, s[28:31], s66 offen sc1
    v_mfma_f32_16x16x32_bf16 v[160:163], v[128:131], v[96:99], v[160:163]
    v_mfma_f32_16x16x32_bf16 v[192:195], v[128:131], v[100:103], v[192:195]
    v_mfma_f32_16x16x32_bf16 v[188:191], v[124:127], v[100:103], v[188:191]
    v_mfma_f32_16x16x32_bf16 v[184:187], v[120:123], v[100:103], v[184:187]
    s_waitcnt lgkmcnt(0)
    v_mfma_f32_16x16x32_bf16 v[180:183], v[116:119], v[100:103], v[180:183]
    v_mfma_f32_16x16x32_bf16 v[196:199], v[116:119], v[104:107], v[196:199]
    v_mfma_f32_16x16x32_bf16 v[200:203], v[120:123], v[104:107], v[200:203]
    v_mfma_f32_16x16x32_bf16 v[204:207], v[124:127], v[104:107], v[204:207]
    s_waitcnt lgkmcnt(0)
    s_barrier
    v_mfma_f32_16x16x32_bf16 v[208:211], v[128:131], v[104:107], v[208:211]
    ds_read_b128 v[164:167], v244 offset:0
    ds_read_b128 v[168:171], v244 offset:2048
    v_mfma_f32_16x16x32_bf16 v[224:227], v[128:131], v[108:111], v[224:227]
    ds_read_b128 v[172:175], v244 offset:4096
    ds_read_b128 v[176:179], v244 offset:6144
    v_mfma_f32_16x16x32_bf16 v[220:223], v[124:127], v[108:111], v[220:223]
    ds_read_b64_tr_b16 v[96:97], v248 offset:0
    ds_read_b64_tr_b16 v[98:99], v248 offset:1280
    v_mfma_f32_16x16x32_bf16 v[216:219], v[120:123], v[108:111], v[216:219]
    ds_read_b64_tr_b16 v[100:101], v249 offset:32
    ds_read_b64_tr_b16 v[102:103], v249 offset:1312
    v_mfma_f32_16x16x32_bf16 v[212:215], v[116:119], v[108:111], v[212:215]
    ds_read_b64_tr_b16 v[104:105], v248 offset:64
    ds_read_b64_tr_b16 v[106:107], v248 offset:1344
    v_mfma_f32_16x16x32_bf16 v[228:231], v[116:119], v[112:115], v[228:231]
    ds_read_b64_tr_b16 v[108:109], v249 offset:96
    v_mfma_f32_16x16x32_bf16 v[232:235], v[120:123], v[112:115], v[232:235]
    ds_read_b64_tr_b16 v[110:111], v249 offset:1376
    v_mfma_f32_16x16x32_bf16 v[236:239], v[124:127], v[112:115], v[236:239]
    v_mfma_f32_16x16x32_bf16 v[240:243], v[128:131], v[112:115], v[240:243]
    ds_read_b64_tr_b16 v[112:113], v248 offset:128
    ds_read_b64_tr_b16 v[114:115], v248 offset:1408
    s_waitcnt lgkmcnt(8)
    v_mfma_f32_16x16x32_bf16 v[148:151], v[164:167], v[96:99], v[148:151]
    ds_read_b128 v[116:119], v245 offset:0
    v_mfma_f32_16x16x32_bf16 v[152:155], v[168:171], v[96:99], v[152:155]
    ds_read_b128 v[120:123], v245 offset:2048
    s_waitcnt lgkmcnt(8)
    v_mfma_f32_16x16x32_bf16 v[156:159], v[172:175], v[96:99], v[156:159]
    ds_read_b128 v[124:127], v245 offset:4096
    s_waitcnt lgkmcnt(7)
    v_mfma_f32_16x16x32_bf16 v[160:163], v[176:179], v[96:99], v[160:163]
    ds_read_b64_tr_b16 v[96:97], v248 offset:10240
    v_mfma_f32_16x16x32_bf16 v[192:195], v[176:179], v[100:103], v[192:195]
    ds_read_b64_tr_b16 v[98:99], v248 offset:11520
    v_mfma_f32_16x16x32_bf16 v[188:191], v[172:175], v[100:103], v[188:191]
    ds_read_b128 v[128:131], v245 offset:6144
    v_mfma_f32_16x16x32_bf16 v[184:187], v[168:171], v[100:103], v[184:187]
    s_waitcnt lgkmcnt(6)
    v_mfma_f32_16x16x32_bf16 v[180:183], v[164:167], v[100:103], v[180:183]
    ds_read_b64_tr_b16 v[100:101], v249 offset:10272
    v_mfma_f32_16x16x32_bf16 v[196:199], v[164:167], v[104:107], v[196:199]
    ds_read_b64_tr_b16 v[102:103], v249 offset:11552
    v_mfma_f32_16x16x32_bf16 v[200:203], v[168:171], v[104:107], v[200:203]
    v_mfma_f32_16x16x32_bf16 v[204:207], v[172:175], v[104:107], v[204:207]
    v_mfma_f32_16x16x32_bf16 v[208:211], v[176:179], v[104:107], v[208:211]
    ds_read_b64_tr_b16 v[104:105], v248 offset:10304
    v_mfma_f32_16x16x32_bf16 v[224:227], v[176:179], v[108:111], v[224:227]
    ds_read_b64_tr_b16 v[106:107], v248 offset:11584
    v_mfma_f32_16x16x32_bf16 v[220:223], v[172:175], v[108:111], v[220:223]
    v_mfma_f32_16x16x32_bf16 v[216:219], v[168:171], v[108:111], v[216:219]
    v_mfma_f32_16x16x32_bf16 v[212:215], v[164:167], v[108:111], v[212:215]
    ds_read_b64_tr_b16 v[108:109], v249 offset:10336
    v_mfma_f32_16x16x32_bf16 v[228:231], v[164:167], v[112:115], v[228:231]
    ds_read_b64_tr_b16 v[110:111], v249 offset:11616
    v_mfma_f32_16x16x32_bf16 v[232:235], v[168:171], v[112:115], v[232:235]
    v_mfma_f32_16x16x32_bf16 v[236:239], v[172:175], v[112:115], v[236:239]
    v_mfma_f32_16x16x32_bf16 v[240:243], v[176:179], v[112:115], v[240:243]
    ds_read_b64_tr_b16 v[112:113], v248 offset:10368
    ds_read_b64_tr_b16 v[114:115], v248 offset:11648
    s_waitcnt lgkmcnt(4)
    v_mfma_f32_16x16x32_bf16 v[148:151], v[116:119], v[96:99], v[148:151]
    v_mfma_f32_16x16x32_bf16 v[152:155], v[120:123], v[96:99], v[152:155]
    s_mov_b32 s71, 0
    v_mfma_f32_16x16x32_bf16 v[156:159], v[124:127], v[96:99], v[156:159]
    v_mfma_f32_16x16x32_bf16 v[160:163], v[128:131], v[96:99], v[160:163]
    v_mfma_f32_16x16x32_bf16 v[192:195], v[128:131], v[100:103], v[192:195]
    v_mfma_f32_16x16x32_bf16 v[188:191], v[124:127], v[100:103], v[188:191]
    v_mfma_f32_16x16x32_bf16 v[184:187], v[120:123], v[100:103], v[184:187]
    s_waitcnt lgkmcnt(0)
    v_mfma_f32_16x16x32_bf16 v[180:183], v[116:119], v[100:103], v[180:183]
    v_mfma_f32_16x16x32_bf16 v[196:199], v[116:119], v[104:107], v[196:199]
    v_cvt_pk_bf16_f32 v148, v148, v149
    v_cvt_pk_bf16_f32 v149, v150, v151
    v_mfma_f32_16x16x32_bf16 v[200:203], v[120:123], v[104:107], v[200:203]
    v_cvt_pk_bf16_f32 v150, v152, v153
    v_cvt_pk_bf16_f32 v151, v154, v155
    v_mfma_f32_16x16x32_bf16 v[204:207], v[124:127], v[104:107], v[204:207]
    v_cvt_pk_bf16_f32 v156, v156, v157
    v_cvt_pk_bf16_f32 v157, v158, v159
    v_mfma_f32_16x16x32_bf16 v[208:211], v[128:131], v[104:107], v[208:211]
    v_cvt_pk_bf16_f32 v158, v160, v161
    v_cvt_pk_bf16_f32 v159, v162, v163
    v_mfma_f32_16x16x32_bf16 v[224:227], v[128:131], v[108:111], v[224:227]
    v_cvt_pk_bf16_f32 v180, v180, v181
    v_cvt_pk_bf16_f32 v181, v182, v183
    v_mfma_f32_16x16x32_bf16 v[220:223], v[124:127], v[108:111], v[220:223]
    v_cvt_pk_bf16_f32 v182, v184, v185
    v_cvt_pk_bf16_f32 v183, v186, v187
    v_mfma_f32_16x16x32_bf16 v[216:219], v[120:123], v[108:111], v[216:219]
    v_cvt_pk_bf16_f32 v188, v188, v189
    v_cvt_pk_bf16_f32 v189, v190, v191
    v_mfma_f32_16x16x32_bf16 v[212:215], v[116:119], v[108:111], v[212:215]
    v_cvt_pk_bf16_f32 v190, v192, v193
    v_cvt_pk_bf16_f32 v191, v194, v195
    v_mfma_f32_16x16x32_bf16 v[228:231], v[116:119], v[112:115], v[228:231]
    v_cvt_pk_bf16_f32 v196, v196, v197
    v_cvt_pk_bf16_f32 v197, v198, v199
    v_mfma_f32_16x16x32_bf16 v[232:235], v[120:123], v[112:115], v[232:235]
    s_waitcnt lgkmcnt(0)
    s_barrier
    v_cvt_pk_bf16_f32 v198, v200, v201
    v_mfma_f32_16x16x32_bf16 v[236:239], v[124:127], v[112:115], v[236:239]
    ds_read_b128 v[132:135], v14 offset:0
    v_cvt_pk_bf16_f32 v199, v202, v203
    v_mfma_f32_16x16x32_bf16 v[240:243], v[128:131], v[112:115], v[240:243]
    ds_read_b128 v[136:139], v14 offset:1024
    ds_read_b128 v[140:143], v14 offset:2048
    ds_read_b128 v[144:147], v14 offset:3072
    s_waitcnt lgkmcnt(3)
    v_mfma_f32_16x16x32_bf16 v[16:19], v[148:151], v[132:135], 0
    v_cvt_pk_bf16_f32 v204, v204, v205
    v_cvt_pk_bf16_f32 v205, v206, v207
    s_waitcnt lgkmcnt(2)
    v_mfma_f32_16x16x32_bf16 v[20:23], v[148:151], v[136:139], 0
    v_cvt_pk_bf16_f32 v206, v208, v209
    v_cvt_pk_bf16_f32 v207, v210, v211
    s_waitcnt lgkmcnt(1)
    v_mfma_f32_16x16x32_bf16 v[24:27], v[156:159], v[140:143], 0
    v_cvt_pk_bf16_f32 v212, v212, v213
    v_cvt_pk_bf16_f32 v213, v214, v215
    s_waitcnt lgkmcnt(0)
    v_mfma_f32_16x16x32_bf16 v[28:31], v[156:159], v[144:147], 0
    v_cvt_pk_bf16_f32 v214, v216, v217
    v_cvt_pk_bf16_f32 v215, v218, v219
    v_mfma_f32_16x16x32_bf16 v[32:35], v[180:183], v[132:135], 0
    v_cvt_pk_bf16_f32 v220, v220, v221
    v_cvt_pk_bf16_f32 v221, v222, v223
    v_mfma_f32_16x16x32_bf16 v[36:39], v[180:183], v[136:139], 0
    v_cvt_pk_bf16_f32 v222, v224, v225
    v_cvt_pk_bf16_f32 v223, v226, v227
    v_mfma_f32_16x16x32_bf16 v[40:43], v[188:191], v[140:143], 0
    v_cvt_pk_bf16_f32 v228, v228, v229
    v_cvt_pk_bf16_f32 v229, v230, v231
    v_mfma_f32_16x16x32_bf16 v[44:47], v[188:191], v[144:147], 0
    v_cvt_pk_bf16_f32 v230, v232, v233
    v_cvt_pk_bf16_f32 v231, v234, v235
    v_mfma_f32_16x16x32_bf16 v[48:51], v[196:199], v[132:135], 0
    v_cvt_pk_bf16_f32 v236, v236, v237
    v_cvt_pk_bf16_f32 v237, v238, v239
    v_mfma_f32_16x16x32_bf16 v[52:55], v[196:199], v[136:139], 0
    v_cvt_pk_bf16_f32 v238, v240, v241
    v_cvt_pk_bf16_f32 v239, v242, v243
    v_mfma_f32_16x16x32_bf16 v[56:59], v[204:207], v[140:143], 0
    ds_read_b128 v[164:167], v244 offset:40960
    ds_read_b128 v[168:171], v244 offset:43008
    v_mfma_f32_16x16x32_bf16 v[60:63], v[204:207], v[144:147], 0
    ds_read_b128 v[172:175], v244 offset:45056
    ds_read_b128 v[176:179], v244 offset:47104
    v_mfma_f32_16x16x32_bf16 v[64:67], v[212:215], v[132:135], 0
    ds_read_b64_tr_b16 v[96:97], v248 offset:40960
    ds_read_b64_tr_b16 v[98:99], v248 offset:42240
    v_mfma_f32_16x16x32_bf16 v[68:71], v[212:215], v[136:139], 0
    ds_read_b64_tr_b16 v[100:101], v249 offset:40992
    ds_read_b64_tr_b16 v[102:103], v249 offset:42272
    v_mfma_f32_16x16x32_bf16 v[72:75], v[220:223], v[140:143], 0
    ds_read_b64_tr_b16 v[104:105], v248 offset:41024
    ds_read_b64_tr_b16 v[106:107], v248 offset:42304
    v_mfma_f32_16x16x32_bf16 v[76:79], v[220:223], v[144:147], 0
    ds_read_b64_tr_b16 v[108:109], v249 offset:41056
    ds_read_b64_tr_b16 v[110:111], v249 offset:42336
    v_mfma_f32_16x16x32_bf16 v[80:83], v[228:231], v[132:135], 0
    ds_read_b64_tr_b16 v[112:113], v248 offset:41088
    ds_read_b64_tr_b16 v[114:115], v248 offset:42368
    v_mfma_f32_16x16x32_bf16 v[84:87], v[228:231], v[136:139], 0
    v_mfma_f32_16x16x32_bf16 v[88:91], v[236:239], v[140:143], 0
    v_mfma_f32_16x16x32_bf16 v[92:95], v[236:239], v[144:147], 0
    v_xor_b32 v14, 253952, v14
L_p2:
    s_waitcnt lgkmcnt(6)
    v_mfma_f32_16x16x32_bf16 v[148:151], v[164:167], v[96:99], 0
    ds_read_b128 v[116:119], v245 offset:40960
    v_mfma_f32_16x16x32_bf16 v[152:155], v[168:171], v[96:99], 0
    ds_read_b128 v[120:123], v245 offset:43008
    v_mfma_f32_16x16x32_bf16 v[156:159], v[172:175], v[96:99], 0
    ds_read_b128 v[124:127], v245 offset:45056
    s_waitcnt lgkmcnt(6)
    v_mfma_f32_16x16x32_bf16 v[160:163], v[176:179], v[96:99], 0
    ds_read_b64_tr_b16 v[96:97], v248 offset:51200
    v_mfma_f32_16x16x32_bf16 v[192:195], v[176:179], v[100:103], 0
    ds_read_b64_tr_b16 v[98:99], v248 offset:52480
    v_mfma_f32_16x16x32_bf16 v[188:191], v[172:175], v[100:103], 0
    ds_read_b128 v[128:131], v245 offset:47104
    v_mfma_f32_16x16x32_bf16 v[184:187], v[168:171], v[100:103], 0
    s_waitcnt lgkmcnt(6)
    v_mfma_f32_16x16x32_bf16 v[180:183], v[164:167], v[100:103], 0
    ds_read_b64_tr_b16 v[100:101], v249 offset:51232
    v_mfma_f32_16x16x32_bf16 v[196:199], v[164:167], v[104:107], 0
    ds_read_b64_tr_b16 v[102:103], v249 offset:52512
    v_mfma_f32_16x16x32_bf16 v[200:203], v[168:171], v[104:107], 0
    v_mfma_f32_16x16x32_bf16 v[204:207], v[172:175], v[104:107], 0
    v_mfma_f32_16x16x32_bf16 v[208:211], v[176:179], v[104:107], 0
    ds_read_b64_tr_b16 v[104:105], v248 offset:51264
    v_mfma_f32_16x16x32_bf16 v[224:227], v[176:179], v[108:111], 0
    ds_read_b64_tr_b16 v[106:107], v248 offset:52544
    v_mfma_f32_16x16x32_bf16 v[220:223], v[172:175], v[108:111], 0
    v_mfma_f32_16x16x32_bf16 v[216:219], v[168:171], v[108:111], 0
    v_mfma_f32_16x16x32_bf16 v[212:215], v[164:167], v[108:111], 0
    ds_read_b64_tr_b16 v[108:109], v249 offset:51296
    v_mfma_f32_16x16x32_bf16 v[228:231], v[164:167], v[112:115], 0
    ds_read_b64_tr_b16 v[110:111], v249 offset:52576
    v_mfma_f32_16x16x32_bf16 v[232:235], v[168:171], v[112:115], 0
    v_mfma_f32_16x16x32_bf16 v[236:239], v[172:175], v[112:115], 0
    v_mfma_f32_16x16x32_bf16 v[240:243], v[176:179], v[112:115], 0
    ds_read_b64_tr_b16 v[112:113], v248 offset:51328
    ds_read_b64_tr_b16 v[114:115], v248 offset:52608
    s_waitcnt lgkmcnt(4)
    v_mfma_f32_16x16x32_bf16 v[148:151], v[116:119], v[96:99], v[148:151]
    v_mfma_f32_16x16x32_bf16 v[152:155], v[120:123], v[96:99], v[152:155]
    v_mfma_f32_16x16x32_bf16 v[156:159], v[124:127], v[96:99], v[156:159]
    v_mfma_f32_16x16x32_bf16 v[160:163], v[128:131], v[96:99], v[160:163]
    v_mfma_f32_16x16x32_bf16 v[192:195], v[128:131], v[100:103], v[192:195]
    s_waitcnt lgkmcnt(0)
    s_barrier
    v_mfma_f32_16x16x32_bf16 v[188:191], v[124:127], v[100:103], v[188:191]
    ds_read_b128 v[164:167], v246 offset:0
    v_mfma_f32_16x16x32_bf16 v[184:187], v[120:123], v[100:103], v[184:187]
    ds_read_b128 v[168:171], v246 offset:2048
    v_mfma_f32_16x16x32_bf16 v[180:183], v[116:119], v[100:103], v[180:183]
    ds_read_b128 v[172:175], v246 offset:4096
    ds_read_b128 v[176:179], v246 offset:6144
    v_mfma_f32_16x16x32_bf16 v[196:199], v[116:119], v[104:107], v[196:199]
    ds_read_b64_tr_b16 v[96:97], v250 offset:0
    ds_read_b64_tr_b16 v[98:99], v250 offset:1280
    v_mfma_f32_16x16x32_bf16 v[200:203], v[120:123], v[104:107], v[200:203]
    ds_read_b64_tr_b16 v[100:101], v251 offset:32
    v_mfma_f32_16x16x32_bf16 v[204:207], v[124:127], v[104:107], v[204:207]
    ds_read_b64_tr_b16 v[102:103], v251 offset:1312
    v_mfma_f32_16x16x32_bf16 v[208:211], v[128:131], v[104:107], v[208:211]
    ds_read_b64_tr_b16 v[104:105], v250 offset:64
    v_mfma_f32_16x16x32_bf16 v[224:227], v[128:131], v[108:111], v[224:227]
    ds_read_b64_tr_b16 v[106:107], v250 offset:1344
    v_mfma_f32_16x16x32_bf16 v[220:223], v[124:127], v[108:111], v[220:223]
    v_mfma_f32_16x16x32_bf16 v[216:219], v[120:123], v[108:111], v[216:219]
    v_mfma_f32_16x16x32_bf16 v[212:215], v[116:119], v[108:111], v[212:215]
    ds_read_b64_tr_b16 v[108:109], v251 offset:96
    v_mfma_f32_16x16x32_bf16 v[228:231], v[116:119], v[112:115], v[228:231]
    ds_read_b64_tr_b16 v[110:111], v251 offset:1376
    v_mfma_f32_16x16x32_bf16 v[232:235], v[120:123], v[112:115], v[232:235]
    v_mfma_f32_16x16x32_bf16 v[236:239], v[124:127], v[112:115], v[236:239]
    v_mfma_f32_16x16x32_bf16 v[240:243], v[128:131], v[112:115], v[240:243]
    ds_read_b64_tr_b16 v[112:113], v250 offset:128
    ds_read_b64_tr_b16 v[114:115], v250 offset:1408
    s_waitcnt lgkmcnt(4)
    v_mfma_f32_16x16x32_bf16 v[148:151], v[164:167], v[96:99], v[148:151]
    ds_read_b128 v[116:119], v247 offset:0
    v_mfma_f32_16x16x32_bf16 v[152:155], v[168:171], v[96:99], v[152:155]
    ds_read_b128 v[120:123], v247 offset:2048
    v_mfma_f32_16x16x32_bf16 v[156:159], v[172:175], v[96:99], v[156:159]
    ds_read_b128 v[124:127], v247 offset:4096
    v_mfma_f32_16x16x32_bf16 v[160:163], v[176:179], v[96:99], v[160:163]
    ds_read_b64_tr_b16 v[96:97], v250 offset:10240
    v_mfma_f32_16x16x32_bf16 v[192:195], v[176:179], v[100:103], v[192:195]
    ds_read_b64_tr_b16 v[98:99], v250 offset:11520
    v_mfma_f32_16x16x32_bf16 v[188:191], v[172:175], v[100:103], v[188:191]
    ds_read_b128 v[128:131], v247 offset:6144
    v_mfma_f32_16x16x32_bf16 v[184:187], v[168:171], v[100:103], v[184:187]
    s_waitcnt lgkmcnt(6)
    v_mfma_f32_16x16x32_bf16 v[180:183], v[164:167], v[100:103], v[180:183]
    ds_read_b64_tr_b16 v[100:101], v251 offset:10272
    v_mfma_f32_16x16x32_bf16 v[196:199], v[164:167], v[104:107], v[196:199]
    ds_read_b64_tr_b16 v[102:103], v251 offset:11552
    v_mfma_f32_16x16x32_bf16 v[200:203], v[168:171], v[104:107], v[200:203]
    v_mfma_f32_16x16x32_bf16 v[204:207], v[172:175], v[104:107], v[204:207]
    v_mfma_f32_16x16x32_bf16 v[208:211], v[176:179], v[104:107], v[208:211]
    ds_read_b64_tr_b16 v[104:105], v250 offset:10304
    v_mfma_f32_16x16x32_bf16 v[224:227], v[176:179], v[108:111], v[224:227]
    ds_read_b64_tr_b16 v[106:107], v250 offset:11584
    v_mfma_f32_16x16x32_bf16 v[220:223], v[172:175], v[108:111], v[220:223]
    v_mfma_f32_16x16x32_bf16 v[216:219], v[168:171], v[108:111], v[216:219]
    v_mfma_f32_16x16x32_bf16 v[212:215], v[164:167], v[108:111], v[212:215]
    ds_read_b64_tr_b16 v[108:109], v251 offset:10336
    v_mfma_f32_16x16x32_bf16 v[228:231], v[164:167], v[112:115], v[228:231]
    ds_read_b64_tr_b16 v[110:111], v251 offset:11616
    v_mfma_f32_16x16x32_bf16 v[232:235], v[168:171], v[112:115], v[232:235]
    v_mfma_f32_16x16x32_bf16 v[236:239], v[172:175], v[112:115], v[236:239]
    v_mfma_f32_16x16x32_bf16 v[240:243], v[176:179], v[112:115], v[240:243]
    ds_read_b64_tr_b16 v[112:113], v250 offset:10368
    ds_read_b64_tr_b16 v[114:115], v250 offset:11648
    s_waitcnt lgkmcnt(4)
    v_mfma_f32_16x16x32_bf16 v[148:151], v[116:119], v[96:99], v[148:151]
    v_mfma_f32_16x16x32_bf16 v[152:155], v[120:123], v[96:99], v[152:155]
    v_mfma_f32_16x16x32_bf16 v[156:159], v[124:127], v[96:99], v[156:159]
    v_mfma_f32_16x16x32_bf16 v[160:163], v[128:131], v[96:99], v[160:163]
    v_mfma_f32_16x16x32_bf16 v[192:195], v[128:131], v[100:103], v[192:195]
    v_mfma_f32_16x16x32_bf16 v[188:191], v[124:127], v[100:103], v[188:191]
    v_mfma_f32_16x16x32_bf16 v[184:187], v[120:123], v[100:103], v[184:187]
    s_waitcnt lgkmcnt(0)
    v_mfma_f32_16x16x32_bf16 v[180:183], v[116:119], v[100:103], v[180:183]
    v_mfma_f32_16x16x32_bf16 v[196:199], v[116:119], v[104:107], v[196:199]
    v_mfma_f32_16x16x32_bf16 v[200:203], v[120:123], v[104:107], v[200:203]
    v_mfma_f32_16x16x32_bf16 v[204:207], v[124:127], v[104:107], v[204:207]
    s_waitcnt lgkmcnt(0)
    s_barrier
    v_mfma_f32_16x16x32_bf16 v[208:211], v[128:131], v[104:107], v[208:211]
    ds_read_b128 v[164:167], v244 offset:0
    ds_read_b128 v[168:171], v244 offset:2048
    v_mfma_f32_16x16x32_bf16 v[224:227], v[128:131], v[108:111], v[224:227]
    ds_read_b128 v[172:175], v244 offset:4096
    ds_read_b128 v[176:179], v244 offset:6144
    v_mfma_f32_16x16x32_bf16 v[220:223], v[124:127], v[108:111], v[220:223]
    ds_read_b64_tr_b16 v[96:97], v248 offset:0
    ds_read_b64_tr_b16 v[98:99], v248 offset:1280
    v_mfma_f32_16x16x32_bf16 v[216:219], v[120:123], v[108:111], v[216:219]
    ds_read_b64_tr_b16 v[100:101], v249 offset:32
    ds_read_b64_tr_b16 v[102:103], v249 offset:1312
    v_mfma_f32_16x16x32_bf16 v[212:215], v[116:119], v[108:111], v[212:215]
    ds_read_b64_tr_b16 v[104:105], v248 offset:64
    ds_read_b64_tr_b16 v[106:107], v248 offset:1344
    v_mfma_f32_16x16x32_bf16 v[228:231], v[116:119], v[112:115], v[228:231]
    ds_read_b64_tr_b16 v[108:109], v249 offset:96
    v_mfma_f32_16x16x32_bf16 v[232:235], v[120:123], v[112:115], v[232:235]
    ds_read_b64_tr_b16 v[110:111], v249 offset:1376
    v_mfma_f32_16x16x32_bf16 v[236:239], v[124:127], v[112:115], v[236:239]
    v_mfma_f32_16x16x32_bf16 v[240:243], v[128:131], v[112:115], v[240:243]
    ds_read_b64_tr_b16 v[112:113], v248 offset:128
    ds_read_b64_tr_b16 v[114:115], v248 offset:1408
    s_waitcnt lgkmcnt(8)
    v_mfma_f32_16x16x32_bf16 v[148:151], v[164:167], v[96:99], v[148:151]
    ds_read_b128 v[116:119], v245 offset:0
    v_mfma_f32_16x16x32_bf16 v[152:155], v[168:171], v[96:99], v[152:155]
    ds_read_b128 v[120:123], v245 offset:2048
    s_waitcnt lgkmcnt(8)
    v_mfma_f32_16x16x32_bf16 v[156:159], v[172:175], v[96:99], v[156:159]
    ds_read_b128 v[124:127], v245 offset:4096
    s_waitcnt lgkmcnt(7)
    v_mfma_f32_16x16x32_bf16 v[160:163], v[176:179], v[96:99], v[160:163]
    ds_read_b64_tr_b16 v[96:97], v248 offset:10240
    v_mfma_f32_16x16x32_bf16 v[192:195], v[176:179], v[100:103], v[192:195]
    ds_read_b64_tr_b16 v[98:99], v248 offset:11520
    v_mfma_f32_16x16x32_bf16 v[188:191], v[172:175], v[100:103], v[188:191]
    ds_read_b128 v[128:131], v245 offset:6144
    v_mfma_f32_16x16x32_bf16 v[184:187], v[168:171], v[100:103], v[184:187]
    s_waitcnt lgkmcnt(6)
    v_mfma_f32_16x16x32_bf16 v[180:183], v[164:167], v[100:103], v[180:183]
    ds_read_b64_tr_b16 v[100:101], v249 offset:10272
    v_mfma_f32_16x16x32_bf16 v[196:199], v[164:167], v[104:107], v[196:199]
    ds_read_b64_tr_b16 v[102:103], v249 offset:11552
    v_mfma_f32_16x16x32_bf16 v[200:203], v[168:171], v[104:107], v[200:203]
    v_mfma_f32_16x16x32_bf16 v[204:207], v[172:175], v[104:107], v[204:207]
    v_mfma_f32_16x16x32_bf16 v[208:211], v[176:179], v[104:107], v[208:211]
    ds_read_b64_tr_b16 v[104:105], v248 offset:10304
    v_mfma_f32_16x16x32_bf16 v[224:227], v[176:179], v[108:111], v[224:227]
    ds_read_b64_tr_b16 v[106:107], v248 offset:11584
    v_mfma_f32_16x16x32_bf16 v[220:223], v[172:175], v[108:111], v[220:223]
    v_mfma_f32_16x16x32_bf16 v[216:219], v[168:171], v[108:111], v[216:219]
    v_mfma_f32_16x16x32_bf16 v[212:215], v[164:167], v[108:111], v[212:215]
    ds_read_b64_tr_b16 v[108:109], v249 offset:10336
    v_mfma_f32_16x16x32_bf16 v[228:231], v[164:167], v[112:115], v[228:231]
    ds_read_b64_tr_b16 v[110:111], v249 offset:11616
    v_mfma_f32_16x16x32_bf16 v[232:235], v[168:171], v[112:115], v[232:235]
    v_mfma_f32_16x16x32_bf16 v[236:239], v[172:175], v[112:115], v[236:239]
    v_mfma_f32_16x16x32_bf16 v[240:243], v[176:179], v[112:115], v[240:243]
    ds_read_b64_tr_b16 v[112:113], v248 offset:10368
    ds_read_b64_tr_b16 v[114:115], v248 offset:11648
    s_waitcnt lgkmcnt(4)
    v_mfma_f32_16x16x32_bf16 v[148:151], v[116:119], v[96:99], v[148:151]
    s_add_u32 s71, s71, 1
    v_mfma_f32_16x16x32_bf16 v[152:155], v[120:123], v[96:99], v[152:155]
    v_mfma_f32_16x16x32_bf16 v[156:159], v[124:127], v[96:99], v[156:159]
    v_mfma_f32_16x16x32_bf16 v[160:163], v[128:131], v[96:99], v[160:163]
    v_mfma_f32_16x16x32_bf16 v[192:195], v[128:131], v[100:103], v[192:195]
    v_mfma_f32_16x16x32_bf16 v[188:191], v[124:127], v[100:103], v[188:191]
    v_mfma_f32_16x16x32_bf16 v[184:187], v[120:123], v[100:103], v[184:187]
    s_waitcnt lgkmcnt(0)
    v_mfma_f32_16x16x32_bf16 v[180:183], v[116:119], v[100:103], v[180:183]
    v_mfma_f32_16x16x32_bf16 v[196:199], v[116:119], v[104:107], v[196:199]
    v_cvt_pk_bf16_f32 v148, v148, v149
    v_cvt_pk_bf16_f32 v149, v150, v151
    v_mfma_f32_16x16x32_bf16 v[200:203], v[120:123], v[104:107], v[200:203]
    v_cvt_pk_bf16_f32 v150, v152, v153
    v_cvt_pk_bf16_f32 v151, v154, v155
    v_mfma_f32_16x16x32_bf16 v[204:207], v[124:127], v[104:107], v[204:207]
    v_cvt_pk_bf16_f32 v156, v156, v157
    v_cvt_pk_bf16_f32 v157, v158, v159
    v_mfma_f32_16x16x32_bf16 v[208:211], v[128:131], v[104:107], v[208:211]
    v_cvt_pk_bf16_f32 v158, v160, v161
    v_cvt_pk_bf16_f32 v159, v162, v163
    v_mfma_f32_16x16x32_bf16 v[224:227], v[128:131], v[108:111], v[224:227]
    v_cvt_pk_bf16_f32 v180, v180, v181
    v_cvt_pk_bf16_f32 v181, v182, v183
    v_mfma_f32_16x16x32_bf16 v[220:223], v[124:127], v[108:111], v[220:223]
    v_cvt_pk_bf16_f32 v182, v184, v185
    v_cvt_pk_bf16_f32 v183, v186, v187
    v_mfma_f32_16x16x32_bf16 v[216:219], v[120:123], v[108:111], v[216:219]
    v_cvt_pk_bf16_f32 v188, v188, v189
    v_cvt_pk_bf16_f32 v189, v190, v191
    v_mfma_f32_16x16x32_bf16 v[212:215], v[116:119], v[108:111], v[212:215]
    v_cvt_pk_bf16_f32 v190, v192, v193
    v_cvt_pk_bf16_f32 v191, v194, v195
    v_mfma_f32_16x16x32_bf16 v[228:231], v[116:119], v[112:115], v[228:231]
    v_cvt_pk_bf16_f32 v196, v196, v197
    v_cvt_pk_bf16_f32 v197, v198, v199
    v_mfma_f32_16x16x32_bf16 v[232:235], v[120:123], v[112:115], v[232:235]
    s_waitcnt lgkmcnt(0)
    s_barrier
    v_cvt_pk_bf16_f32 v198, v200, v201
    v_mfma_f32_16x16x32_bf16 v[236:239], v[124:127], v[112:115], v[236:239]
    ds_read_b128 v[132:135], v14 offset:0
    v_cvt_pk_bf16_f32 v199, v202, v203
    v_mfma_f32_16x16x32_bf16 v[240:243], v[128:131], v[112:115], v[240:243]
    ds_read_b128 v[136:139], v14 offset:1024
    ds_read_b128 v[140:143], v14 offset:2048
    ds_read_b128 v[144:147], v14 offset:3072
    s_waitcnt lgkmcnt(3)
    v_mfma_f32_16x16x32_bf16 v[16:19], v[148:151], v[132:135], v[16:19]
    v_cvt_pk_bf16_f32 v204, v204, v205
    v_cvt_pk_bf16_f32 v205, v206, v207
    s_waitcnt lgkmcnt(2)
    v_mfma_f32_16x16x32_bf16 v[20:23], v[148:151], v[136:139], v[20:23]
    v_cvt_pk_bf16_f32 v206, v208, v209
    v_cvt_pk_bf16_f32 v207, v210, v211
    s_waitcnt lgkmcnt(1)
    v_mfma_f32_16x16x32_bf16 v[24:27], v[156:159], v[140:143], v[24:27]
    v_cvt_pk_bf16_f32 v212, v212, v213
    v_cvt_pk_bf16_f32 v213, v214, v215
    s_waitcnt lgkmcnt(0)
    v_mfma_f32_16x16x32_bf16 v[28:31], v[156:159], v[144:147], v[28:31]
    v_cvt_pk_bf16_f32 v214, v216, v217
    v_cvt_pk_bf16_f32 v215, v218, v219
    v_mfma_f32_16x16x32_bf16 v[32:35], v[180:183], v[132:135], v[32:35]
    v_cvt_pk_bf16_f32 v220, v220, v221
    v_cvt_pk_bf16_f32 v221, v222, v223
    v_mfma_f32_16x16x32_bf16 v[36:39], v[180:183], v[136:139], v[36:39]
    v_cvt_pk_bf16_f32 v222, v224, v225
    v_cvt_pk_bf16_f32 v223, v226, v227
    v_mfma_f32_16x16x32_bf16 v[40:43], v[188:191], v[140:143], v[40:43]
    v_cvt_pk_bf16_f32 v228, v228, v229
    v_cvt_pk_bf16_f32 v229, v230, v231
    v_mfma_f32_16x16x32_bf16 v[44:47], v[188:191], v[144:147], v[44:47]
    v_cvt_pk_bf16_f32 v230, v232, v233
    v_cvt_pk_bf16_f32 v231, v234, v235
    v_mfma_f32_16x16x32_bf16 v[48:51], v[196:199], v[132:135], v[48:51]
    v_cvt_pk_bf16_f32 v236, v236, v237
    v_cvt_pk_bf16_f32 v237, v238, v239
    v_mfma_f32_16x16x32_bf16 v[52:55], v[196:199], v[136:139], v[52:55]
    v_cvt_pk_bf16_f32 v238, v240, v241
    v_cvt_pk_bf16_f32 v239, v242, v243
    v_mfma_f32_16x16x32_bf16 v[56:59], v[204:207], v[140:143], v[56:59]
    ds_read_b128 v[164:167], v244 offset:40960
    ds_read_b128 v[168:171], v244 offset:43008
    v_mfma_f32_16x16x32_bf16 v[60:63], v[204:207], v[144:147], v[60:63]
    ds_read_b128 v[172:175], v244 offset:45056
    ds_read_b128 v[176:179], v244 offset:47104
    v_mfma_f32_16x16x32_bf16 v[64:67], v[212:215], v[132:135], v[64:67]
    ds_read_b64_tr_b16 v[96:97], v248 offset:40960
    ds_read_b64_tr_b16 v[98:99], v248 offset:42240
    v_mfma_f32_16x16x32_bf16 v[68:71], v[212:215], v[136:139], v[68:71]
    ds_read_b64_tr_b16 v[100:101], v249 offset:40992
    ds_read_b64_tr_b16 v[102:103], v249 offset:42272
    v_mfma_f32_16x16x32_bf16 v[72:75], v[220:223], v[140:143], v[72:75]
    ds_read_b64_tr_b16 v[104:105], v248 offset:41024
    ds_read_b64_tr_b16 v[106:107], v248 offset:42304
    v_mfma_f32_16x16x32_bf16 v[76:79], v[220:223], v[144:147], v[76:79]
    ds_read_b64_tr_b16 v[108:109], v249 offset:41056
    ds_read_b64_tr_b16 v[110:111], v249 offset:42336
    v_mfma_f32_16x16x32_bf16 v[80:83], v[228:231], v[132:135], v[80:83]
    ds_read_b64_tr_b16 v[112:113], v248 offset:41088
    ds_read_b64_tr_b16 v[114:115], v248 offset:42368
    v_mfma_f32_16x16x32_bf16 v[84:87], v[228:231], v[136:139], v[84:87]
    v_mfma_f32_16x16x32_bf16 v[88:91], v[236:239], v[140:143], v[88:91]
    s_cmp_lt_u32 s71, 2
    v_mfma_f32_16x16x32_bf16 v[92:95], v[236:239], v[144:147], v[92:95]
    v_xor_b32 v14, 253952, v14
    s_cbranch_scc1 L_p2
    s_waitcnt lgkmcnt(4)
    v_mfma_f32_16x16x32_bf16 v[148:151], v[164:167], v[96:99], 0
    ds_read_b128 v[116:119], v245 offset:40960
    s_and_b32 s57, s41, 2
    v_mfma_f32_16x16x32_bf16 v[152:155], v[168:171], v[96:99], 0
    ds_read_b128 v[120:123], v245 offset:43008
    s_add_u32 s57, s57, s41
    v_mfma_f32_16x16x32_bf16 v[156:159], v[172:175], v[96:99], 0
    ds_read_b128 v[124:127], v245 offset:45056
    s_lshl1_add_u32 s57, s65, s57
    v_mfma_f32_16x16x32_bf16 v[160:163], v[176:179], v[96:99], 0
    ds_read_b64_tr_b16 v[96:97], v248 offset:51200
    s_lshl2_add_u32 s4, s42, s40
    v_mfma_f32_16x16x32_bf16 v[180:183], v[164:167], v[100:103], 0
    ds_read_b64_tr_b16 v[98:99], v248 offset:52480
    s_lshl3_add_u32 s4, s4, s57
    v_mfma_f32_16x16x32_bf16 v[184:187], v[168:171], v[100:103], 0
    ds_read_b128 v[128:131], v245 offset:47104
    s_mul_i32 s4, s4, 40960
    v_mfma_f32_16x16x32_bf16 v[188:191], v[172:175], v[100:103], 0
    s_mul_i32 s5, s39, 5120
    s_add_u32 s4, s4, s5
    v_mfma_f32_16x16x32_bf16 v[192:195], v[176:179], v[100:103], 0
    ds_read_b64_tr_b16 v[100:101], v249 offset:51232
    s_add_u32 s4, s4, 4194304
    v_mfma_f32_16x16x32_bf16 v[196:199], v[164:167], v[104:107], 0
    ds_read_b64_tr_b16 v[102:103], v249 offset:52512
    s_mul_i32 s5, s65, 163840
    v_mfma_f32_16x16x32_bf16 v[200:203], v[168:171], v[104:107], 0
    s_sub_u32 s5, s4, s5
    s_add_u32 s5, s5, 81920
    v_mfma_f32_16x16x32_bf16 v[204:207], v[172:175], v[104:107], 0
    s_add_u32 s6, s4, 4096
    s_add_u32 s7, s5, 4096
    v_mfma_f32_16x16x32_bf16 v[208:211], v[176:179], v[104:107], 0
    ds_read_b64_tr_b16 v[104:105], v248 offset:51264
    s_andn2_b32 s56, s73, 0x380
    s_waitcnt lgkmcnt(3)
    v_mfma_f32_16x16x32_bf16 v[212:215], v[164:167], v[108:111], 0
    ds_read_b64_tr_b16 v[106:107], v248 offset:52544
    s_lshl_b32 s47, s57, 7
    v_mfma_f32_16x16x32_bf16 v[216:219], v[168:171], v[108:111], 0
    s_add_u32 s56, s56, s47
    s_lshl_b32 s47, s39, 2
    v_mfma_f32_16x16x32_bf16 v[220:223], v[172:175], v[108:111], 0
    s_add_u32 s56, s56, s47
    s_mov_b32 s58, s56
    v_mfma_f32_16x16x32_bf16 v[224:227], v[176:179], v[108:111], 0
    ds_read_b64_tr_b16 v[108:109], v249 offset:51296
    s_xor_b32 s56, s56, 256
    v_mfma_f32_16x16x32_bf16 v[228:231], v[164:167], v[112:115], 0
    ds_read_b64_tr_b16 v[110:111], v249 offset:52576
    v_mov_b32 v252, 0
    v_mfma_f32_16x16x32_bf16 v[232:235], v[168:171], v[112:115], 0
    v_min_u32 v253, 1, v0
    v_lshlrev_b32 v253, 31, v253
    v_mfma_f32_16x16x32_bf16 v[236:239], v[172:175], v[112:115], 0
    s_xor_b32 s57, s39, s57
    v_add_u32 v3, 139264, v13
    v_mfma_f32_16x16x32_bf16 v[240:243], v[176:179], v[112:115], 0
    ds_read_b64_tr_b16 v[112:113], v248 offset:51328
    s_cmp_eq_u32 s57, 0
    v_mfma_f32_16x16x32_bf16 v[148:151], v[116:119], v[96:99], v[148:151]
    ds_read_b64_tr_b16 v[114:115], v248 offset:52608
    s_cselect_b32 s47, 0x80000000, 0
    v_mfma_f32_16x16x32_bf16 v[152:155], v[120:123], v[96:99], v[152:155]
    v_or_b32 v1, s47, v13
    s_cmp_eq_u32 s57, 2
    s_barrier
    v_mfma_f32_16x16x32_bf16 v[156:159], v[124:127], v[96:99], v[156:159]
    s_cselect_b32 s47, 0x80000000, 0
    v_or_b32 v2, s47, v13
    v_mfma_f32_16x16x32_bf16 v[160:163], v[128:131], v[96:99], v[160:163]
    ds_read_b128 v[164:167], v246 offset:0
    s_waitcnt lgkmcnt(3)
    v_mfma_f32_16x16x32_bf16 v[180:183], v[116:119], v[100:103], v[180:183]
    ds_read_b64_tr_b16 v[96:97], v250 offset:0
    v_mfma_f32_16x16x32_bf16 v[184:187], v[120:123], v[100:103], v[184:187]
    ds_read_b64_tr_b16 v[98:99], v250 offset:1280
    v_mfma_f32_16x16x32_bf16 v[188:191], v[124:127], v[100:103], v[188:191]
    ds_read_b128 v[168:171], v246 offset:2048
    v_mfma_f32_16x16x32_bf16 v[192:195], v[128:131], v[100:103], v[192:195]
    ds_read_b128 v[172:175], v247 offset:0
    v_mfma_f32_16x16x32_bf16 v[196:199], v[116:119], v[104:107], v[196:199]
    ds_read_b64_tr_b16 v[100:101], v250 offset:10240
    v_mfma_f32_16x16x32_bf16 v[200:203], v[120:123], v[104:107], v[200:203]
    ds_read_b64_tr_b16 v[102:103], v250 offset:11520
    v_mfma_f32_16x16x32_bf16 v[204:207], v[124:127], v[104:107], v[204:207]
    ds_read_b128 v[176:179], v247 offset:2048
    s_waitcnt lgkmcnt(5)
    v_mfma_f32_16x16x32_bf16 v[208:211], v[128:131], v[104:107], v[208:211]
    ds_read_b64_tr_b16 v[104:105], v251 offset:32
    v_mfma_f32_16x16x32_bf16 v[212:215], v[116:119], v[108:111], v[212:215]
    ds_read_b64_tr_b16 v[106:107], v251 offset:1312
    v_mfma_f32_16x16x32_bf16 v[216:219], v[120:123], v[108:111], v[216:219]
    ds_read_b128 v[132:135], v14 offset:0
    v_mfma_f32_16x16x32_bf16 v[220:223], v[124:127], v[108:111], v[220:223]
    ds_read_b128 v[136:139], v14 offset:1024
    v_mfma_f32_16x16x32_bf16 v[224:227], v[128:131], v[108:111], v[224:227]
    ds_read_b64_tr_b16 v[108:109], v251 offset:10272
    s_waitcnt lgkmcnt(5)
    v_mfma_f32_16x16x32_bf16 v[228:231], v[116:119], v[112:115], v[228:231]
    ds_read_b64_tr_b16 v[110:111], v251 offset:11552
    v_mfma_f32_16x16x32_bf16 v[232:235], v[120:123], v[112:115], v[232:235]
    ds_read_b128 v[140:143], v14 offset:2048
    v_mfma_f32_16x16x32_bf16 v[236:239], v[124:127], v[112:115], v[236:239]
    ds_read_b128 v[144:147], v14 offset:3072
    s_waitcnt lgkmcnt(5)
    v_mfma_f32_16x16x32_bf16 v[240:243], v[128:131], v[112:115], v[240:243]
    ds_read_b64_tr_b16 v[112:113], v250 offset:64
    v_mfma_f32_16x16x32_bf16 v[148:151], v[164:167], v[96:99], v[148:151]
    ds_read_b64_tr_b16 v[114:115], v250 offset:1344
    v_mfma_f32_16x16x32_bf16 v[152:155], v[168:171], v[96:99], v[152:155]
    ds_read_b64_tr_b16 v[96:97], v250 offset:10304
    s_waitcnt lgkmcnt(5)
    v_mfma_f32_16x16x32_bf16 v[148:151], v[172:175], v[100:103], v[148:151]
    ds_read_b64_tr_b16 v[98:99], v250 offset:11584
    v_mfma_f32_16x16x32_bf16 v[152:155], v[176:179], v[100:103], v[152:155]
    v_mfma_f32_16x16x32_bf16 v[180:183], v[164:167], v[104:107], v[180:183]
    s_barrier
    v_mfma_f32_16x16x32_bf16 v[184:187], v[168:171], v[104:107], v[184:187]
    ds_read_b128 v[116:119], v244 offset:0
    ds_read_b64_tr_b16 v[100:101], v248 offset:0
    v_mfma_f32_16x16x32_bf16 v[180:183], v[172:175], v[108:111], v[180:183]
    ds_read_b64_tr_b16 v[102:103], v248 offset:1280
    ds_read_b128 v[120:123], v244 offset:2048
    v_mfma_f32_16x16x32_bf16 v[184:187], v[176:179], v[108:111], v[184:187]
    ds_read_b128 v[124:127], v245 offset:0
    ds_read_b64_tr_b16 v[104:105], v248 offset:10240
    s_waitcnt lgkmcnt(6)
    v_mfma_f32_16x16x32_bf16 v[196:199], v[164:167], v[112:115], v[196:199]
    ds_read_b64_tr_b16 v[106:107], v248 offset:11520
    ds_read_b128 v[128:131], v245 offset:2048
    v_mfma_f32_16x16x32_bf16 v[200:203], v[168:171], v[112:115], v[200:203]
    ds_read_b64_tr_b16 v[108:109], v249 offset:32
    ds_read_b64_tr_b16 v[110:111], v249 offset:1312
    v_mfma_f32_16x16x32_bf16 v[196:199], v[172:175], v[96:99], v[196:199]
    ds_read_b64_tr_b16 v[112:113], v249 offset:10272
    v_mfma_f32_16x16x32_bf16 v[200:203], v[176:179], v[96:99], v[200:203]
    ds_read_b64_tr_b16 v[114:115], v249 offset:11552
    s_waitcnt lgkmcnt(8)
    v_mfma_f32_16x16x32_bf16 v[148:151], v[116:119], v[100:103], v[148:151]
    ds_read_b64_tr_b16 v[96:97], v248 offset:64
    v_mfma_f32_16x16x32_bf16 v[152:155], v[120:123], v[100:103], v[152:155]
    ds_read_b64_tr_b16 v[98:99], v248 offset:1344
    s_waitcnt lgkmcnt(6)
    v_mfma_f32_16x16x32_bf16 v[148:151], v[124:127], v[104:107], v[148:151]
    ds_read_b64_tr_b16 v[100:101], v248 offset:10304
    s_waitcnt lgkmcnt(5)
    v_mfma_f32_16x16x32_bf16 v[152:155], v[128:131], v[104:107], v[152:155]
    ds_read_b64_tr_b16 v[102:103], v248 offset:11584
    v_mfma_f32_16x16x32_bf16 v[180:183], v[116:119], v[108:111], v[180:183]
    ds_read_b64_tr_b16 v[104:105], v251 offset:96
    s_waitcnt lgkmcnt(5)
    v_mfma_f32_16x16x32_bf16 v[184:187], v[120:123], v[108:111], v[184:187]
    ds_read_b64_tr_b16 v[106:107], v251 offset:1376
    v_cvt_pk_bf16_f32 v148, v148, v149
    v_mfma_f32_16x16x32_bf16 v[180:183], v[124:127], v[112:115], v[180:183]
    ds_read_b64_tr_b16 v[108:109], v251 offset:10336
    v_cvt_pk_bf16_f32 v149, v150, v151
    v_mfma_f32_16x16x32_bf16 v[184:187], v[128:131], v[112:115], v[184:187]
    ds_read_b64_tr_b16 v[110:111], v251 offset:11616
    v_cvt_pk_bf16_f32 v150, v152, v153
    s_waitcnt lgkmcnt(5)
    v_mfma_f32_16x16x32_bf16 v[196:199], v[116:119], v[96:99], v[196:199]
    ds_read_b64_tr_b16 v[112:113], v249 offset:96
    v_cvt_pk_bf16_f32 v151, v154, v155
    v_mfma_f32_16x16x32_bf16 v[200:203], v[120:123], v[96:99], v[200:203]
    ds_read_b64_tr_b16 v[114:115], v249 offset:1376
    v_cvt_pk_bf16_f32 v180, v180, v181
    v_mfma_f32_16x16x32_bf16 v[16:19], v[148:151], v[132:135], v[16:19]
    ds_read_b64_tr_b16 v[96:97], v249 offset:10336
    v_cvt_pk_bf16_f32 v181, v182, v183
    s_waitcnt lgkmcnt(5)
    v_mfma_f32_16x16x32_bf16 v[196:199], v[124:127], v[100:103], v[196:199]
    ds_read_b64_tr_b16 v[98:99], v249 offset:11616
    v_cvt_pk_bf16_f32 v182, v184, v185
    v_mfma_f32_16x16x32_bf16 v[20:23], v[148:151], v[136:139], v[20:23]
    ds_read_b128 v[152:155], v246 offset:4096
    v_cvt_pk_bf16_f32 v183, v186, v187
    v_mfma_f32_16x16x32_bf16 v[200:203], v[128:131], v[100:103], v[200:203]
    ds_read_b64_tr_b16 v[100:101], v250 offset:128
    s_waitcnt lgkmcnt(5)
    v_mfma_f32_16x16x32_bf16 v[212:215], v[164:167], v[104:107], v[212:215]
    ds_read_b64_tr_b16 v[102:103], v250 offset:1408
    v_cvt_pk_bf16_f32 v196, v196, v197
    v_mfma_f32_16x16x32_bf16 v[216:219], v[168:171], v[104:107], v[216:219]
    ds_read_b64_tr_b16 v[104:105], v250 offset:10368
    v_cvt_pk_bf16_f32 v197, v198, v199
    v_mfma_f32_16x16x32_bf16 v[32:35], v[180:183], v[132:135], v[32:35]
    ds_read_b64_tr_b16 v[106:107], v250 offset:11648
    v_cvt_pk_bf16_f32 v198, v200, v201
    v_mfma_f32_16x16x32_bf16 v[212:215], v[172:175], v[108:111], v[212:215]
    ds_read_b128 v[148:151], v246 offset:6144
    v_cvt_pk_bf16_f32 v199, v202, v203
    v_mfma_f32_16x16x32_bf16 v[36:39], v[180:183], v[136:139], v[36:39]
    ds_read_b128 v[184:187], v247 offset:4096
    v_cvt_pk_bf16_f32 v16, v16, v17
    v_mfma_f32_16x16x32_bf16 v[216:219], v[176:179], v[108:111], v[216:219]
    ds_read_b64_tr_b16 v[108:109], v248 offset:128
    v_cvt_pk_bf16_f32 v17, v18, v19
    s_waitcnt lgkmcnt(5)
    v_mfma_f32_16x16x32_bf16 v[212:215], v[116:119], v[112:115], v[212:215]
    ds_read_b64_tr_b16 v[110:111], v248 offset:1408
    v_cvt_pk_bf16_f32 v18, v20, v21
    v_mfma_f32_16x16x32_bf16 v[216:219], v[120:123], v[112:115], v[216:219]
    ds_read_b64_tr_b16 v[112:113], v248 offset:10368
    v_cvt_pk_bf16_f32 v19, v22, v23
    v_mfma_f32_16x16x32_bf16 v[48:51], v[196:199], v[132:135], v[48:51]
    buffer_store_dwordx4 v[16:19], v1, s[28:31], s4 offen offset:0 sc1
    v_cvt_pk_bf16_f32 v32, v32, v33
    v_mfma_f32_16x16x32_bf16 v[212:215], v[124:127], v[96:99], v[212:215]
    ds_read_b64_tr_b16 v[114:115], v248 offset:11648
    v_cvt_pk_bf16_f32 v33, v34, v35
    v_mfma_f32_16x16x32_bf16 v[52:55], v[196:199], v[136:139], v[52:55]
    ds_read_b128 v[180:183], v247 offset:6144
    v_cvt_pk_bf16_f32 v34, v36, v37
    v_mfma_f32_16x16x32_bf16 v[216:219], v[128:131], v[96:99], v[216:219]
    ds_read_b64_tr_b16 v[96:97], v250 offset:0
    v_cvt_pk_bf16_f32 v35, v38, v39
    v_mfma_f32_16x16x32_bf16 v[228:231], v[164:167], v[100:103], v[228:231]
    v_cvt_pk_bf16_f32 v212, v212, v213
    buffer_store_dwordx4 v[32:35], v1, s[28:31], s4 offen offset:1024 sc1
    v_mfma_f32_16x16x32_bf16 v[232:235], v[168:171], v[100:103], v[232:235]
    ds_read_b64_tr_b16 v[98:99], v250 offset:1280
    v_cvt_pk_bf16_f32 v213, v214, v215
    s_waitcnt lgkmcnt(4)
    v_mfma_f32_16x16x32_bf16 v[228:231], v[172:175], v[104:107], v[228:231]
    ds_read_b64_tr_b16 v[100:101], v250 offset:10240
    v_cvt_pk_bf16_f32 v214, v216, v217
    v_mfma_f32_16x16x32_bf16 v[232:235], v[176:179], v[104:107], v[232:235]
    ds_read_b64_tr_b16 v[102:103], v250 offset:11520
    v_cvt_pk_bf16_f32 v215, v218, v219
    v_mfma_f32_16x16x32_bf16 v[228:231], v[116:119], v[108:111], v[228:231]
    ds_read_b128 v[200:203], v244 offset:4096
    v_cvt_pk_bf16_f32 v48, v48, v49
    v_mfma_f32_16x16x32_bf16 v[232:235], v[120:123], v[108:111], v[232:235]
    ds_read_b64_tr_b16 v[104:105], v248 offset:0
    v_cvt_pk_bf16_f32 v49, v50, v51
    v_mfma_f32_16x16x32_bf16 v[64:67], v[212:215], v[132:135], v[64:67]
    ds_read_b64_tr_b16 v[106:107], v248 offset:1280
    v_cvt_pk_bf16_f32 v50, v52, v53
    s_waitcnt lgkmcnt(5)
    v_mfma_f32_16x16x32_bf16 v[228:231], v[124:127], v[112:115], v[228:231]
    ds_read_b128 v[196:199], v244 offset:6144
    v_cvt_pk_bf16_f32 v51, v54, v55
    v_mfma_f32_16x16x32_bf16 v[68:71], v[212:215], v[136:139], v[68:71]
    buffer_store_dwordx4 v[48:51], v1, s[28:31], s4 offen offset:2048 sc1
    ds_read_b64_tr_b16 v[108:109], v248 offset:10240
    v_mfma_f32_16x16x32_bf16 v[232:235], v[128:131], v[112:115], v[232:235]
    ds_read_b64_tr_b16 v[110:111], v248 offset:11520
    s_waitcnt lgkmcnt(5)
    v_mfma_f32_16x16x32_bf16 v[156:159], v[152:155], v[96:99], v[156:159]
    ds_read_b128 v[216:219], v245 offset:4096
    v_cvt_pk_bf16_f32 v228, v228, v229
    v_mfma_f32_16x16x32_bf16 v[160:163], v[148:151], v[96:99], v[160:163]
    ds_read_b128 v[212:215], v245 offset:6144
    v_cvt_pk_bf16_f32 v229, v230, v231
    v_mfma_f32_16x16x32_bf16 v[156:159], v[184:187], v[100:103], v[156:159]
    ds_read_b64_tr_b16 v[112:113], v251 offset:32
    v_cvt_pk_bf16_f32 v230, v232, v233
    v_mfma_f32_16x16x32_bf16 v[160:163], v[180:183], v[100:103], v[160:163]
    ds_read_b64_tr_b16 v[114:115], v251 offset:1312
    v_cvt_pk_bf16_f32 v231, v234, v235
    s_waitcnt lgkmcnt(5)
    v_mfma_f32_16x16x32_bf16 v[156:159], v[200:203], v[104:107], v[156:159]
    ds_read_b64_tr_b16 v[96:97], v251 offset:10272
    v_cvt_pk_bf16_f32 v64, v64, v65
    v_mfma_f32_16x16x32_bf16 v[160:163], v[196:199], v[104:107], v[160:163]
    ds_read_b64_tr_b16 v[98:99], v251 offset:11552
    v_cvt_pk_bf16_f32 v65, v66, v67
    v_mfma_f32_16x16x32_bf16 v[80:83], v[228:231], v[132:135], v[80:83]
    ds_read_b64_tr_b16 v[100:101], v249 offset:32
    v_cvt_pk_bf16_f32 v66, v68, v69
    s_waitcnt lgkmcnt(5)
    v_mfma_f32_16x16x32_bf16 v[156:159], v[216:219], v[108:111], v[156:159]
    ds_read_b64_tr_b16 v[102:103], v249 offset:1312
    v_cvt_pk_bf16_f32 v67, v70, v71
    v_mfma_f32_16x16x32_bf16 v[84:87], v[228:231], v[136:139], v[84:87]
    buffer_store_dwordx4 v[64:67], v1, s[28:31], s4 offen offset:3072 sc1
    ds_read_b64_tr_b16 v[104:105], v249 offset:10272
    v_mfma_f32_16x16x32_bf16 v[160:163], v[212:215], v[108:111], v[160:163]
    ds_read_b64_tr_b16 v[106:107], v249 offset:11552
    s_waitcnt lgkmcnt(5)
    v_mfma_f32_16x16x32_bf16 v[188:191], v[152:155], v[112:115], v[188:191]
    ds_read_b64_tr_b16 v[108:109], v250 offset:64
    v_cvt_pk_bf16_f32 v156, v156, v157
    v_mfma_f32_16x16x32_bf16 v[192:195], v[148:151], v[112:115], v[192:195]
    ds_read_b64_tr_b16 v[110:111], v250 offset:1344
    v_cvt_pk_bf16_f32 v157, v158, v159
    s_waitcnt lgkmcnt(5)
    v_mfma_f32_16x16x32_bf16 v[188:191], v[184:187], v[96:99], v[188:191]
    ds_read_b64_tr_b16 v[112:113], v250 offset:10304
    v_cvt_pk_bf16_f32 v158, v160, v161
    v_mfma_f32_16x16x32_bf16 v[192:195], v[180:183], v[96:99], v[192:195]
    ds_read_b64_tr_b16 v[114:115], v250 offset:11584
    v_cvt_pk_bf16_f32 v159, v162, v163
    s_waitcnt lgkmcnt(5)
    v_mfma_f32_16x16x32_bf16 v[188:191], v[200:203], v[100:103], v[188:191]
    ds_read_b64_tr_b16 v[96:97], v248 offset:64
    v_cvt_pk_bf16_f32 v80, v80, v81
    v_mfma_f32_16x16x32_bf16 v[192:195], v[196:199], v[100:103], v[192:195]
    ds_read_b64_tr_b16 v[98:99], v248 offset:1344
    v_cvt_pk_bf16_f32 v81, v82, v83
    v_mfma_f32_16x16x32_bf16 v[24:27], v[156:159], v[140:143], v[24:27]
    ds_read_b64_tr_b16 v[100:101], v248 offset:10304
    v_cvt_pk_bf16_f32 v82, v84, v85
    s_waitcnt lgkmcnt(5)
    v_mfma_f32_16x16x32_bf16 v[188:191], v[216:219], v[104:107], v[188:191]
    ds_read_b64_tr_b16 v[102:103], v248 offset:11584
    v_cvt_pk_bf16_f32 v83, v86, v87
    v_mfma_f32_16x16x32_bf16 v[28:31], v[156:159], v[144:147], v[28:31]
    buffer_store_dwordx4 v[80:83], v1, s[28:31], s6 offen offset:0 sc1
    s_waitcnt lgkmcnt(4)
    v_mfma_f32_16x16x32_bf16 v[192:195], v[212:215], v[104:107], v[192:195]
    ds_read_b64_tr_b16 v[104:105], v251 offset:96
    v_mfma_f32_16x16x32_bf16 v[204:207], v[152:155], v[108:111], v[204:207]
    ds_read_b64_tr_b16 v[106:107], v251 offset:1376
    v_cvt_pk_bf16_f32 v188, v188, v189
    v_mfma_f32_16x16x32_bf16 v[208:211], v[148:151], v[108:111], v[208:211]
    ds_read_b64_tr_b16 v[108:109], v251 offset:10336
    v_cvt_pk_bf16_f32 v189, v190, v191
    v_mfma_f32_16x16x32_bf16 v[204:207], v[184:187], v[112:115], v[204:207]
    ds_read_b64_tr_b16 v[110:111], v251 offset:11616
    v_cvt_pk_bf16_f32 v190, v192, v193
    v_mfma_f32_16x16x32_bf16 v[208:211], v[180:183], v[112:115], v[208:211]
    ds_read_b64_tr_b16 v[112:113], v249 offset:96
    v_cvt_pk_bf16_f32 v191, v194, v195
    s_waitcnt lgkmcnt(5)
    v_mfma_f32_16x16x32_bf16 v[204:207], v[200:203], v[96:99], v[204:207]
    ds_read_b64_tr_b16 v[114:115], v249 offset:1376
    v_cvt_pk_bf16_f32 v24, v24, v25
    v_mfma_f32_16x16x32_bf16 v[208:211], v[196:199], v[96:99], v[208:211]
    ds_read_b64_tr_b16 v[96:97], v249 offset:10336
    v_cvt_pk_bf16_f32 v25, v26, v27
    v_mfma_f32_16x16x32_bf16 v[40:43], v[188:191], v[140:143], v[40:43]
    ds_read_b64_tr_b16 v[98:99], v249 offset:11616
    v_cvt_pk_bf16_f32 v26, v28, v29
    v_mfma_f32_16x16x32_bf16 v[204:207], v[216:219], v[100:103], v[204:207]
    v_cvt_pk_bf16_f32 v27, v30, v31
    s_waitcnt lgkmcnt(4)
    v_mfma_f32_16x16x32_bf16 v[44:47], v[188:191], v[144:147], v[44:47]
    buffer_store_dwordx4 v[24:27], v2, s[28:31], s5 offen offset:0 sc1
    v_mfma_f32_16x16x32_bf16 v[208:211], v[212:215], v[100:103], v[208:211]
    ds_read_b64_tr_b16 v[100:101], v250 offset:128
    s_waitcnt lgkmcnt(3)
    v_mfma_f32_16x16x32_bf16 v[220:223], v[152:155], v[104:107], v[220:223]
    ds_read_b64_tr_b16 v[102:103], v250 offset:1408
    v_cvt_pk_bf16_f32 v204, v204, v205
    v_mfma_f32_16x16x32_bf16 v[224:227], v[148:151], v[104:107], v[224:227]
    ds_read_b64_tr_b16 v[104:105], v250 offset:10368
    v_cvt_pk_bf16_f32 v205, v206, v207
    v_mfma_f32_16x16x32_bf16 v[220:223], v[184:187], v[108:111], v[220:223]
    ds_read_b64_tr_b16 v[106:107], v250 offset:11648
    v_cvt_pk_bf16_f32 v206, v208, v209
    v_mfma_f32_16x16x32_bf16 v[224:227], v[180:183], v[108:111], v[224:227]
    ds_read_b64_tr_b16 v[108:109], v248 offset:128
    v_cvt_pk_bf16_f32 v207, v210, v211
    v_mfma_f32_16x16x32_bf16 v[220:223], v[200:203], v[112:115], v[220:223]
    ds_read_b64_tr_b16 v[110:111], v248 offset:1408
    v_cvt_pk_bf16_f32 v40, v40, v41
    v_mfma_f32_16x16x32_bf16 v[224:227], v[196:199], v[112:115], v[224:227]
    ds_read_b64_tr_b16 v[112:113], v248 offset:10368
    v_cvt_pk_bf16_f32 v41, v42, v43
    v_mfma_f32_16x16x32_bf16 v[56:59], v[204:207], v[140:143], v[56:59]
    ds_read_b64_tr_b16 v[114:115], v248 offset:11648
    v_cvt_pk_bf16_f32 v42, v44, v45
    s_waitcnt lgkmcnt(5)
    v_mfma_f32_16x16x32_bf16 v[220:223], v[216:219], v[96:99], v[220:223]
    v_cvt_pk_bf16_f32 v43, v46, v47
    s_waitcnt lgkmcnt(4)
    v_mfma_f32_16x16x32_bf16 v[60:63], v[204:207], v[144:147], v[60:63]
    buffer_store_dwordx4 v[40:43], v2, s[28:31], s5 offen offset:1024 sc1
    v_mfma_f32_16x16x32_bf16 v[224:227], v[212:215], v[96:99], v[224:227]
    s_waitcnt lgkmcnt(2)
    v_mfma_f32_16x16x32_bf16 v[236:239], v[152:155], v[100:103], v[236:239]
    s_nop 0
    v_cvt_pk_bf16_f32 v220, v220, v221
    v_mfma_f32_16x16x32_bf16 v[240:243], v[148:151], v[100:103], v[240:243]
    v_cvt_pk_bf16_f32 v221, v222, v223
    s_waitcnt lgkmcnt(0)
    v_mfma_f32_16x16x32_bf16 v[236:239], v[184:187], v[104:107], v[236:239]
    v_cvt_pk_bf16_f32 v222, v224, v225
    v_mfma_f32_16x16x32_bf16 v[240:243], v[180:183], v[104:107], v[240:243]
    v_cvt_pk_bf16_f32 v223, v226, v227
    v_mfma_f32_16x16x32_bf16 v[236:239], v[200:203], v[108:111], v[236:239]
    v_cvt_pk_bf16_f32 v56, v56, v57
    v_mfma_f32_16x16x32_bf16 v[240:243], v[196:199], v[108:111], v[240:243]
    v_cvt_pk_bf16_f32 v57, v58, v59
    v_mfma_f32_16x16x32_bf16 v[72:75], v[220:223], v[140:143], v[72:75]
    v_cvt_pk_bf16_f32 v58, v60, v61
    v_mfma_f32_16x16x32_bf16 v[236:239], v[216:219], v[112:115], v[236:239]
    v_cvt_pk_bf16_f32 v59, v62, v63
    v_mfma_f32_16x16x32_bf16 v[76:79], v[220:223], v[144:147], v[76:79]
    buffer_store_dwordx4 v[56:59], v2, s[28:31], s5 offen offset:2048 sc1
    v_mfma_f32_16x16x32_bf16 v[240:243], v[212:215], v[112:115], v[240:243]
    s_nop 1
    v_cvt_pk_bf16_f32 v72, v72, v73
    v_cvt_pk_bf16_f32 v73, v74, v75
    v_cvt_pk_bf16_f32 v236, v236, v237
    v_cvt_pk_bf16_f32 v237, v238, v239
    s_nop 1
    v_cvt_pk_bf16_f32 v238, v240, v241
    v_cvt_pk_bf16_f32 v239, v242, v243
    v_cvt_pk_bf16_f32 v74, v76, v77
    v_cvt_pk_bf16_f32 v75, v78, v79
    v_mfma_f32_16x16x32_bf16 v[88:91], v[236:239], v[140:143], v[88:91]
    buffer_store_dwordx4 v[72:75], v2, s[28:31], s5 offen offset:3072 sc1
    v_mfma_f32_16x16x32_bf16 v[92:95], v[236:239], v[144:147], v[92:95]
    s_nop 5
    v_cvt_pk_bf16_f32 v88, v88, v89
    v_cvt_pk_bf16_f32 v89, v90, v91
    v_cvt_pk_bf16_f32 v90, v92, v93
    v_cvt_pk_bf16_f32 v91, v94, v95
    buffer_store_dwordx4 v[88:91], v2, s[28:31], s7 offen offset:0 sc1
    s_waitcnt vmcnt(5)
    buffer_store_dword v252, v253, s[28:31], s58 offen sc1
    s_cmp_eq_u32 s57, 0
    s_cbranch_scc0 L_self0
    ds_write_b128 v3, v[16:19] offset:0
    ds_write_b128 v3, v[32:35] offset:1024
    ds_write_b128 v3, v[48:51] offset:2048
    ds_write_b128 v3, v[64:67] offset:3072
    ds_write_b128 v3, v[80:83] offset:4096
    s_waitcnt lgkmcnt(0)
L_self0:
    s_cmp_eq_u32 s57, 2
    s_cbranch_scc0 L_self1
    ds_write_b128 v3, v[24:27] offset:0
    ds_write_b128 v3, v[40:43] offset:1024
    ds_write_b128 v3, v[56:59] offset:2048
    ds_write_b128 v3, v[72:75] offset:3072
    ds_write_b128 v3, v[88:91] offset:4096
    s_waitcnt lgkmcnt(0)
L_self1:
    s_barrier
    s_mov_b32 s44, 4
    s_cmp_eq_u32 s41, 3
    s_cbranch_scc1 L_reduce
    s_waitcnt vmcnt(1)
    buffer_store_dword v252, v253, s[28:31], s56 offen sc1
    s_endpgm
L_ev0:
    s_cmp_eq_u32 s71, 0
    s_cbranch_scc0 L_ev0_h
    s_barrier
    ds_read_b64_tr_b16 v[116:117], v5 offset:12288
    ds_read_b64_tr_b16 v[118:119], v5 offset:12800
    ds_read_b64_tr_b16 v[120:121], v6 offset:12288
    ds_read_b64_tr_b16 v[122:123], v6 offset:12800
    ds_read_b64_tr_b16 v[124:125], v7 offset:12288
    ds_read_b64_tr_b16 v[126:127], v7 offset:12800
    ds_read_b64_tr_b16 v[128:129], v8 offset:12288
    ds_read_b64_tr_b16 v[130:131], v8 offset:12800
    ds_read_b64_tr_b16 v[132:133], v5 offset:13312
    ds_read_b64_tr_b16 v[134:135], v5 offset:13824
    ds_read_b64_tr_b16 v[136:137], v6 offset:13312
    ds_read_b64_tr_b16 v[138:139], v6 offset:13824
    s_waitcnt lgkmcnt(15)
L_ev0_h:
    s_mul_i32 s4, s71, 3
    s_add_u32 s4, s4, 0
    s_cmp_eq_u32 s4, s67
    s_cbranch_scc0 L_ev0_c
    s_waitcnt vmcnt(0)
    s_mov_b64 exec, 1
    buffer_atomic_add v252, off, s[32:35], s68 sc1
    s_mov_b64 exec, -1
L_ev0_c:
    s_bitcmp1_b32 s74, 0
    s_cbranch_scc0 L_ev0_0
    ds_read_b64 v[180:181], v112 offset:0
    ds_read_b64 v[182:183], v113 offset:0
    ds_read_b64 v[184:185], v114 offset:0
    ds_read_b64 v[186:187], v115 offset:0
    ds_read_b64 v[188:189], v112 offset:8192
    ds_read_b64 v[190:191], v113 offset:8192
    ds_read_b64 v[192:193], v176 offset:0
    ds_read_b64 v[194:195], v177 offset:0
    ds_read_b64 v[196:197], v178 offset:0
    ds_read_b64 v[198:199], v179 offset:0
    ds_read_b64 v[200:201], v176 offset:8192
    ds_read_b64 v[202:203], v177 offset:8192
    s_branch L_evback0
L_ev0_0:
    s_bitcmp1_b32 s75, 0
    s_cbranch_scc0 L_ev0_1
    ds_read_b64 v[204:205], v112 offset:0
    ds_read_b64 v[206:207], v113 offset:0
    ds_read_b64 v[208:209], v114 offset:0
    ds_read_b64 v[210:211], v115 offset:0
    ds_read_b64 v[212:213], v112 offset:8192
    ds_read_b64 v[214:215], v113 offset:8192
    ds_read_b64 v[216:217], v176 offset:0
    ds_read_b64 v[218:219], v177 offset:0
    ds_read_b64 v[220:221], v178 offset:0
    ds_read_b64 v[222:223], v179 offset:0
    ds_read_b64 v[224:225], v176 offset:8192
    ds_read_b64 v[226:227], v177 offset:8192
    s_branch L_evback0
L_ev0_1:
    s_branch L_evback0
L_ev1:
    s_mul_i32 s4, s71, 3
    s_add_u32 s4, s4, 1
    s_cmp_eq_u32 s4, s67
    s_cbranch_scc0 L_ev1_c
    s_waitcnt vmcnt(0)
    s_mov_b64 exec, 1
    buffer_atomic_add v252, off, s[32:35], s68 sc1
    s_mov_b64 exec, -1
L_ev1_c:
    s_bitcmp1_b32 s74, 1
    s_cbranch_scc0 L_ev1_0
    ds_read_b64 v[180:181], v112 offset:0
    ds_read_b64 v[182:183], v113 offset:0
    ds_read_b64 v[184:185], v114 offset:0
    ds_read_b64 v[186:187], v115 offset:0
    ds_read_b64 v[188:189], v112 offset:8192
    ds_read_b64 v[190:191], v113 offset:8192
    ds_read_b64 v[192:193], v176 offset:0
    ds_read_b64 v[194:195], v177 offset:0
    ds_read_b64 v[196:197], v178 offset:0
    ds_read_b64 v[198:199], v179 offset:0
    ds_read_b64 v[200:201], v176 offset:8192
    ds_read_b64 v[202:203], v177 offset:8192
    s_branch L_evback1
L_ev1_0:
    s_bitcmp1_b32 s75, 1
    s_cbranch_scc0 L_ev1_1
    ds_read_b64 v[204:205], v112 offset:0
    ds_read_b64 v[206:207], v113 offset:0
    ds_read_b64 v[208:209], v114 offset:0
    ds_read_b64 v[210:211], v115 offset:0
    ds_read_b64 v[212:213], v112 offset:8192
    ds_read_b64 v[214:215], v113 offset:8192
    ds_read_b64 v[216:217], v176 offset:0
    ds_read_b64 v[218:219], v177 offset:0
    ds_read_b64 v[220:221], v178 offset:0
    ds_read_b64 v[222:223], v179 offset:0
    ds_read_b64 v[224:225], v176 offset:8192
    ds_read_b64 v[226:227], v177 offset:8192
    s_branch L_evback1
L_ev1_1:
    s_branch L_evback1
L_ev2:
    s_mul_i32 s4, s71, 3
    s_add_u32 s4, s4, 2
    s_cmp_eq_u32 s4, s67
    s_cbranch_scc0 L_ev2_c
    s_waitcnt vmcnt(0)
    s_mov_b64 exec, 1
    buffer_atomic_add v252, off, s[32:35], s68 sc1
    s_mov_b64 exec, -1
L_ev2_c:
    s_bitcmp1_b32 s74, 2
    s_cbranch_scc0 L_ev2_0
    ds_read_b64 v[180:181], v112 offset:0
    ds_read_b64 v[182:183], v113 offset:0
    ds_read_b64 v[184:185], v114 offset:0
    ds_read_b64 v[186:187], v115 offset:0
    ds_read_b64 v[188:189], v112 offset:8192
    ds_read_b64 v[190:191], v113 offset:8192
    ds_read_b64 v[192:193], v176 offset:0
    ds_read_b64 v[194:195], v177 offset:0
    ds_read_b64 v[196:197], v178 offset:0
    ds_read_b64 v[198:199], v179 offset:0
    ds_read_b64 v[200:201], v176 offset:8192
    ds_read_b64 v[202:203], v177 offset:8192
    s_branch L_evback2
L_ev2_0:
    s_bitcmp1_b32 s75, 2
    s_cbranch_scc0 L_ev2_1
    ds_read_b64 v[204:205], v112 offset:0
    ds_read_b64 v[206:207], v113 offset:0
    ds_read_b64 v[208:209], v114 offset:0
    ds_read_b64 v[210:211], v115 offset:0
    ds_read_b64 v[212:213], v112 offset:8192
    ds_read_b64 v[214:215], v113 offset:8192
    ds_read_b64 v[216:217], v176 offset:0
    ds_read_b64 v[218:219], v177 offset:0
    ds_read_b64 v[220:221], v178 offset:0
    ds_read_b64 v[222:223], v179 offset:0
    ds_read_b64 v[224:225], v176 offset:8192
    ds_read_b64 v[226:227], v177 offset:8192
    s_branch L_evback2
L_ev2_1:
    s_branch L_evback2
L_ev3:
    s_bitcmp1_b32 s74, 0
    s_cbranch_scc0 L_ev3_0
    ds_read_b64 v[180:181], v112 offset:0
    ds_read_b64 v[182:183], v113 offset:0
    ds_read_b64 v[184:185], v114 offset:0
    ds_read_b64 v[186:187], v115 offset:0
    ds_read_b64 v[188:189], v112 offset:8192
    ds_read_b64 v[190:191], v113 offset:8192
    ds_read_b64 v[192:193], v176 offset:0
    ds_read_b64 v[194:195], v177 offset:0
    ds_read_b64 v[196:197], v178 offset:0
    ds_read_b64 v[198:199], v179 offset:0
    ds_read_b64 v[200:201], v176 offset:8192
    ds_read_b64 v[202:203], v177 offset:8192
    s_branch L_evback3
L_ev3_0:
    s_bitcmp1_b32 s75, 0
    s_cbranch_scc0 L_ev3_1
    ds_read_b64 v[204:205], v112 offset:0
    ds_read_b64 v[206:207], v113 offset:0
    ds_read_b64 v[208:209], v114 offset:0
    ds_read_b64 v[210:211], v115 offset:0
    ds_read_b64 v[212:213], v112 offset:8192
    ds_read_b64 v[214:215], v113 offset:8192
    ds_read_b64 v[216:217], v176 offset:0
    ds_read_b64 v[218:219], v177 offset:0
    ds_read_b64 v[220:221], v178 offset:0
    ds_read_b64 v[222:223], v179 offset:0
    ds_read_b64 v[224:225], v176 offset:8192
    ds_read_b64 v[226:227], v177 offset:8192
    s_branch L_evback3
L_ev3_1:
    s_branch L_evback3
L_codeend:

.section .rodata,"a"
.p2align 6
.amdhsa_kernel concat_heads__gqa_block_cached__gqa_block_cached__near_ridge_kernel
  .amdhsa_next_free_vgpr 256
  .amdhsa_next_free_sgpr 102
  .amdhsa_accum_offset 256
  .amdhsa_group_segment_fixed_size 0
  .amdhsa_kernarg_size 104
  .amdhsa_user_sgpr_count 2
  .amdhsa_user_sgpr_kernarg_segment_ptr 1
  .amdhsa_system_sgpr_workgroup_id_x 1
.end_amdhsa_kernel
```
